```python
import torch

def _softmax(x, axis=-1):
    return torch.softmax(x, dim=axis)

def _gelu(x):
    return torch.nn.functional.gelu(x, approximate='tanh')

def _silu(x):
    return torch.nn.functional.silu(x)

def _sigmoid(x):
    return torch.sigmoid(x)

def _layernorm(x, axis=-1, eps=1e-05):
    m = x.mean(dim=axis, keepdim=True)
    v = x.var(dim=axis, keepdim=True, unbiased=False)
    return (x - m) / torch.sqrt(v + eps)

def _scatter_add(tgt, idx, src, axis=0):
    return tgt.clone().index_add_(axis, idx, src)

def _segment_sum(src, seg, n):
    out = torch.zeros((n,) + src.shape[1:], dtype=src.dtype)
    return out.index_add_(0, seg, src)

def _pad(x, pw):
    flat = tuple((v for pair in reversed(pw) for v in pair))
    return torch.nn.functional.pad(x, flat)
kernel_name = 'parallel_sum__memory_aug_recurrent_mem_tr__dense_activation_relu__prompt'

def setup_inputs():

    _w = lambda a: (lambda t: t.to(torch.bfloat16) if t.is_floating_point() else t)(torch.as_tensor(a))

    def _A_setup():
        B, S, Dm = (1, 2048, 512)
        H, Dh = (32, 128)
        M, seg = (8, 32)
        seg = min(seg, S)
        S = S // seg * seg
        return {'x': _w((lambda *s: torch.randn(*s, dtype=torch.bfloat16) * 0.05)(B, S, Dm)), 'mem0': _w((lambda *s: torch.randn(*s, dtype=torch.bfloat16) * 1.6)(B, M, Dm)), 'Wq': _w((lambda *s: torch.randn(*s, dtype=torch.bfloat16) * 0.8)(Dm, H, Dh) * Dm ** (-0.5)), 'Wk': _w((lambda *s: torch.randn(*s, dtype=torch.bfloat16) * 0.8)(Dm, H, Dh) * Dm ** (-0.5)), 'Wv': _w((lambda *s: torch.randn(*s, dtype=torch.bfloat16) * 1.6)(Dm, H, Dh) * Dm ** (-0.5)), 'Wo': _w((lambda *s: torch.randn(*s, dtype=torch.bfloat16) * 1.6)(H, Dh, Dm) * (H * Dh) ** (-0.5)), 'seg_len': seg}
    _A_in = _A_setup()

    def _B_setup():
        B, S, D, Dff = (1, 2048, 512, 1792)
        return {'x': _w((lambda *s: torch.randn(*s, dtype=torch.bfloat16) * 0.05)(B, S, D)), 'w1': _w((lambda *s: torch.randn(*s, dtype=torch.bfloat16) * 0.05)(D, Dff)), 'w2': _w((lambda *s: torch.randn(*s, dtype=torch.bfloat16) * 0.05)(Dff, D))}
    _B_in = _B_setup()
    return {'A_x': _A_in['x'], 'A_mem0': _A_in['mem0'], 'A_Wq': _A_in['Wq'], 'A_Wk': _A_in['Wk'], 'A_Wv': _A_in['Wv'], 'A_Wo': _A_in['Wo'], 'A_seg_len': _A_in['seg_len'], 'B_x': _B_in['x'], 'B_w1': _B_in['w1'], 'B_w2': _B_in['w2']}

def reference(A_x, A_mem0, A_Wq, A_Wk, A_Wv, A_Wo, A_seg_len, B_x, B_w1, B_w2):

    def _A_ref(x, mem0, Wq, Wk, Wv, Wo, seg_len):
        B, S, Dm = x.shape
        H, Dh = (Wq.shape[1], Wq.shape[2])
        M = mem0.shape[1]
        scale = Dh ** (-0.5)
        n_seg = S // seg_len
        L = M + seg_len
        idx = torch.arange(L)
        mask = (idx[:, None] < M) | (idx[:, None] >= idx[None, :])
        mem = mem0
        outs = []
        for s in range(n_seg):
            xs = x[:, s * seg_len:(s + 1) * seg_len, :].clone()
            h = torch.concatenate([mem, xs], axis=1)
            q = torch.einsum('btd,dhe->bhte', h, Wq)
            k = torch.einsum('btd,dhe->bhte', h, Wk)
            v = torch.einsum('btd,dhe->bhte', h, Wv)
            scores = torch.einsum('bhqe,bhke->bhqk', q, k) * scale
            scores = torch.where(mask[None, None], scores, -1000000000.0)
            p = _softmax(scores, axis=-1)
            o = torch.einsum('bhqk,bhke->bhqe', p, v)
            o = torch.einsum('bhte,hed->btd', o, Wo)
            mem = o[:, :M, :].clone()
            outs.append(o[:, M:, :])
        return torch.concatenate(outs, axis=1)

    def _B_ref(x, w1, w2):
        h = torch.einsum('bsd,df->bsf', x, w1)
        zero = torch.zeros_like(h)
        h = torch.maximum(h, zero)
        return torch.einsum('bsf,fd->bsd', h, w2)
    x = A_x
    xn = _layernorm(x, axis=-1)
    return x + _A_ref(xn, A_mem0, A_Wq, A_Wk, A_Wv, A_Wo, A_seg_len) + _B_ref(xn, B_w1, B_w2)
```

```asm
; @launch grid=(256,1,1) block=(256,1,1) lds=163840
.amdgcn_target "amdgcn-amd-amdhsa--gfx950"
.text
.globl parallel_sum__memory_aug_recurrent_mem_tr__dense_activation_relu__prompt_kernel
.p2align 8
.type parallel_sum__memory_aug_recurrent_mem_tr__dense_activation_relu__prompt_kernel,@function
parallel_sum__memory_aug_recurrent_mem_tr__dense_activation_relu__prompt_kernel:
  s_cmp_ge_u32 s2, 256
  s_cbranch_scc1 L_end
  s_getreg_b32 s95, hwreg(HW_REG_XCC_ID)
  s_mov_b32 s94, s2
  s_sub_u32 s95, s95, s2
  s_and_b32 s95, s95, 7
  s_cmp_eq_u32 s95, 1
  s_cselect_b32 s3, 3, 1
  s_sub_u32 s95, s95, s3
  s_and_b32 s95, s95, 7
  s_add_u32 s95, s95, 1
L_again:
  s_add_u32 s2, s94, s95
  s_sub_u32 s2, s2, 1
  s_and_b32 s2, s2, 255
  s_load_dwordx16 s[4:19], s[0:1], 0
  s_load_dwordx8 s[20:27], s[0:1], 64
  s_load_dwordx2 s[28:29], s[0:1], 96
  v_lshrrev_b32 v1, 6, v0
  v_and_b32 v2, 63, v0
  v_readfirstlane_b32 s3, v1
  s_waitcnt lgkmcnt(0)
  s_mov_b32 s32, s4
  s_and_b32 s33, s5, 0xffff
  s_mov_b32 s34, 0x200000
  s_mov_b32 s35, 0x20000
  s_mov_b32 s36, s6
  s_and_b32 s37, s7, 0xffff
  s_mov_b32 s38, 0x2000
  s_mov_b32 s39, 0x20000
  s_mov_b32 s40, s8
  s_and_b32 s41, s9, 0xffff
  s_mov_b32 s42, 0x400000
  s_mov_b32 s43, 0x20000
  s_mov_b32 s44, s10
  s_and_b32 s45, s11, 0xffff
  s_mov_b32 s46, 0x400000
  s_mov_b32 s47, 0x20000
  s_mov_b32 s48, s12
  s_and_b32 s49, s13, 0xffff
  s_mov_b32 s50, 0x400000
  s_mov_b32 s51, 0x20000
  s_mov_b32 s52, s14
  s_and_b32 s53, s15, 0xffff
  s_mov_b32 s54, 0x400000
  s_mov_b32 s55, 0x20000
  s_mov_b32 s56, s20
  s_and_b32 s57, s21, 0xffff
  s_mov_b32 s58, 0x1c0000
  s_mov_b32 s59, 0x20000
  s_mov_b32 s60, s22
  s_and_b32 s61, s23, 0xffff
  s_mov_b32 s62, 0x1c0000
  s_mov_b32 s63, 0x20000
  s_mov_b32 s64, s24
  s_and_b32 s65, s25, 0xffff
  s_mov_b32 s66, 0x200000
  s_mov_b32 s67, 0x20000
  s_mov_b32 s68, s26
  s_and_b32 s69, s27, 0xffff
  s_mov_b32 s70, 0x100
  s_mov_b32 s71, 0x20000
  s_mov_b32 s72, s28
  s_and_b32 s73, s29, 0xffff
  s_mov_b32 s74, 0x10000000
  s_mov_b32 s75, 0x20000
  s_mov_b32 s4, s3
  s_cmp_lg_u32 s94, 0
  s_cbranch_scc1 L_noinit
  v_mov_b32 v4, s95
  s_cmp_eq_u32 s4, 0
  s_cselect_b64 exec, 1, 0
  buffer_store_dword v4, off, s[68:71], 0 offset:132 sc1
  s_mov_b64 exec, -1
  v_mov_b32 v4, 0
  v_mov_b32 v5, 0
  v_mov_b32 v6, 0
  v_mov_b32 v7, 0
  v_lshlrev_b32 v3, 4, v0
  buffer_store_dwordx4 v[4:7], v3, s[72:75], 0 offen sc1
  s_mov_b32 s10, 0x2000
  buffer_store_dwordx4 v[4:7], v3, s[72:75], s10 offen sc1
  s_mov_b32 s10, 0x3000
  buffer_store_dwordx4 v[4:7], v3, s[72:75], s10 offen sc1
  s_mov_b32 s10, 0x4000
  buffer_store_dwordx4 v[4:7], v3, s[72:75], s10 offen sc1
  s_mov_b32 s10, 0x5000
  buffer_store_dwordx4 v[4:7], v3, s[72:75], s10 offen sc1
  s_mov_b32 s10, 0x6000
  buffer_store_dwordx4 v[4:7], v3, s[72:75], s10 offen sc1
  s_mov_b32 s10, 0x7000
  buffer_store_dwordx4 v[4:7], v3, s[72:75], s10 offen sc1
  s_waitcnt vmcnt(0)
  s_barrier
  v_mov_b32 v4, s95
  s_cmp_eq_u32 s4, 0
  s_cselect_b64 exec, 1, 0
  buffer_store_dword v4, off, s[68:71], 0 offset:128 sc1
  s_mov_b64 exec, -1
L_noinit:
  v_lshlrev_b32 v1, 4, v2
  s_and_b32 s8, s2, 7
  s_lshr_b32 s5, s2, 3
  s_cmp_eq_u32 s8, 0
  s_cbranch_scc0 L_foll
L_chain:
  s_lshl_b32 s9, s4, 12
  s_lshl_b32 s78, s4, 11
  s_lshl_b32 s34, s5, 2
  s_add_u32 s34, s34, 32768
  s_and_b32 s35, s5, 7
  s_lshl_b32 s35, s35, 8
  s_add_u32 s35, s35, 32768
  s_cmp_eq_u32 s4, 0
  s_cselect_b32 s32, -1, 0
  v_and_b32 v24, 0x70, v0
  v_lshlrev_b32 v24, 1, v24
  v_and_b32 v3, 0xf, v0
  v_lshlrev_b32 v3, 4, v3
  v_xor_b32 v24, v24, v3
  v_and_b32 v3, 0x40, v0
  v_lshlrev_b32 v3, 8, v3
  v_xor_b32 v24, v24, v3
  v_and_b32 v3, 0x80, v0
  v_lshlrev_b32 v3, 9, v3
  v_xor_b32 v24, v24, v3
  v_and_b32 v3, 0x30, v0
  v_lshlrev_b32 v3, 13, v3
  v_xor_b32 v24, v24, v3
  v_and_b32 v37, 0x40, v0
  v_lshlrev_b32 v37, 15, v37
  v_and_b32 v3, 0x8, v0
  v_lshlrev_b32 v3, 18, v3
  v_xor_b32 v37, v37, v3
  v_xor_b32 v38, 0x0, v37
  v_add_u32 v38, v38, v24
  v_xor_b32 v39, 0x100000, v37
  v_add_u32 v39, v39, v24
  v_xor_b32 v40, 0x200000, v37
  v_add_u32 v40, v40, v24
  v_xor_b32 v41, 0x300000, v37
  v_add_u32 v41, v41, v24
  v_and_b32 v25, 0x10, v0
  v_lshlrev_b32 v25, 1, v25
  v_and_b32 v3, 0x60, v0
  v_lshlrev_b32 v3, 3, v3
  v_xor_b32 v25, v25, v3
  v_and_b32 v3, 0x3, v0
  v_lshlrev_b32 v3, 4, v3
  v_xor_b32 v25, v25, v3
  v_and_b32 v3, 0x3c, v0
  v_lshlrev_b32 v3, 6, v3
  v_xor_b32 v25, v25, v3
  v_and_b32 v3, 0xc0, v0
  v_lshlrev_b32 v3, 8, v3
  v_xor_b32 v25, v25, v3
  v_and_b32 v3, 0x40, v0
  v_lshlrev_b32 v3, 10, v3
  v_xor_b32 v25, v25, v3
  v_and_b32 v3, 0x8, v0
  v_lshlrev_b32 v3, 13, v3
  v_xor_b32 v25, v25, v3
  v_xor_b32 v42, 0x10000, v25
  s_lshl_b32 s13, s5, 8
  s_lshl_b32 s12, s5, 17
  s_mov_b32 s88, s9
  s_mov_b32 s89, s12
  s_mov_b32 s90, s13
  s_add_u32 m0, s88, 0x20000
  s_add_u32 s10, s90, 0x0
  buffer_load_dwordx4 v38, s[48:51], s10 offen lds
  s_add_u32 m0, s88, 0x20400
  s_add_u32 s10, s90, 0x2000
  buffer_load_dwordx4 v38, s[48:51], s10 offen lds
  s_add_u32 m0, s88, 0x20800
  s_add_u32 s10, s90, 0x8000
  buffer_load_dwordx4 v38, s[48:51], s10 offen lds
  s_add_u32 m0, s88, 0x20c00
  s_add_u32 s10, s90, 0xa000
  buffer_load_dwordx4 v38, s[48:51], s10 offen lds
  s_add_u32 m0, s88, 0x24000
  s_add_u32 s10, s90, 0x0
  buffer_load_dwordx4 v39, s[48:51], s10 offen lds
  s_add_u32 m0, s88, 0x24400
  s_add_u32 s10, s90, 0x2000
  buffer_load_dwordx4 v39, s[48:51], s10 offen lds
  s_add_u32 m0, s88, 0x24800
  s_add_u32 s10, s90, 0x8000
  buffer_load_dwordx4 v39, s[48:51], s10 offen lds
  s_add_u32 m0, s88, 0x24c00
  s_add_u32 s10, s90, 0xa000
  buffer_load_dwordx4 v39, s[48:51], s10 offen lds
  s_add_u32 m0, s88, 0x0
  s_add_u32 s10, s90, 0x80000
  buffer_load_dwordx4 v38, s[48:51], s10 offen lds
  s_add_u32 m0, s88, 0x400
  s_add_u32 s10, s90, 0x82000
  buffer_load_dwordx4 v38, s[48:51], s10 offen lds
  s_add_u32 m0, s88, 0x800
  s_add_u32 s10, s90, 0x88000
  buffer_load_dwordx4 v38, s[48:51], s10 offen lds
  s_add_u32 m0, s88, 0xc00
  s_add_u32 s10, s90, 0x8a000
  buffer_load_dwordx4 v38, s[48:51], s10 offen lds
  s_add_u32 m0, s88, 0x4000
  s_add_u32 s10, s90, 0x80000
  buffer_load_dwordx4 v39, s[48:51], s10 offen lds
  s_add_u32 m0, s88, 0x4400
  s_add_u32 s10, s90, 0x82000
  buffer_load_dwordx4 v39, s[48:51], s10 offen lds
  s_add_u32 m0, s88, 0x4800
  s_add_u32 s10, s90, 0x88000
  buffer_load_dwordx4 v39, s[48:51], s10 offen lds
  s_add_u32 m0, s88, 0x4c00
  s_add_u32 s10, s90, 0x8a000
  buffer_load_dwordx4 v39, s[48:51], s10 offen lds
  v_and_b32 v26, 0xc0, v0
  v_and_b32 v27, 0x1f, v0
  v_lshlrev_b32 v27, 3, v27
  v_xor_b32 v26, v26, v27
  v_and_b32 v27, 0x2c, v0
  v_lshlrev_b32 v27, 6, v27
  v_xor_b32 v26, v26, v27
  v_and_b32 v27, 0x10, v0
  v_lshlrev_b32 v27, 8, v27
  v_xor_b32 v26, v26, v27
  v_xor_b32 v27, 32, v26
  v_add_u32 v28, 0x10000, v26
  v_add_u32 v29, 0x10000, v27
  v_add_u32 v30, 0x20000, v26
  v_add_u32 v31, 0x20000, v27
  v_and_b32 v56, 0xc0, v0
  v_and_b32 v57, 0x8, v0
  v_lshlrev_b32 v57, 2, v57
  v_xor_b32 v56, v56, v57
  v_and_b32 v57, 0x17, v0
  v_lshlrev_b32 v57, 3, v57
  v_xor_b32 v56, v56, v57
  v_and_b32 v57, 0x24, v0
  v_lshlrev_b32 v57, 6, v57
  v_xor_b32 v56, v56, v57
  v_and_b32 v57, 0x40, v0
  v_lshlrev_b32 v57, 7, v57
  v_xor_b32 v56, v56, v57
  v_and_b32 v57, 0x10, v0
  v_lshlrev_b32 v57, 8, v57
  v_xor_b32 v56, v56, v57
  v_xor_b32 v57, 64, v56
  v_xor_b32 v58, 0x2000, v56
  v_xor_b32 v59, 0x2000, v57
  v_and_b32 v3, 0x3f, v0
  v_lshlrev_b32 v3, 4, v3
  v_and_b32 v12, 0xc0, v0
  v_lshlrev_b32 v12, 5, v12
  v_xor_b32 v3, v3, v12
  v_and_b32 v5, 0xc0, v0
  v_and_b32 v12, 0xf, v0
  v_lshlrev_b32 v12, 2, v12
  v_xor_b32 v5, v5, v12
  v_bfe_u32 v12, v0, 4, 2
  v_mul_u32_u24 v12, 576, v12
  v_add_u32 v5, v5, v12
  v_and_b32 v6, 0xc, v0
  v_lshrrev_b32 v6, 1, v6
  v_and_b32 v12, 0x1, v0
  v_xor_b32 v6, v6, v12
  v_mul_u32_u24 v6, 288, v6
  v_and_b32 v12, 48, v0
  v_add_u32 v6, v6, v12
  v_and_b32 v7, 0x40, v0
  v_lshlrev_b32 v7, 1, v7
  v_and_b32 v12, 0x7, v0
  v_lshlrev_b32 v12, 4, v12
  v_xor_b32 v7, v7, v12
  v_and_b32 v12, 0x38, v0
  v_lshlrev_b32 v12, 5, v12
  v_xor_b32 v7, v7, v12
  v_and_b32 v8, 0x10, v0
  v_lshlrev_b32 v8, 1, v8
  v_and_b32 v12, 0x3, v0
  v_lshlrev_b32 v12, 3, v12
  v_xor_b32 v8, v8, v12
  v_and_b32 v12, 0xe0, v0
  v_lshlrev_b32 v12, 10, v12
  v_xor_b32 v8, v8, v12
  v_and_b32 v12, 0xc, v0
  v_lshlrev_b32 v12, 11, v12
  v_xor_b32 v8, v8, v12
  v_and_b32 v9, 0x20, v0
  v_lshrrev_b32 v9, 3, v9
  v_and_b32 v12, 0x10, v0
  v_xor_b32 v9, v9, v12
  v_and_b32 v12, 0x5, v0
  v_lshlrev_b32 v12, 3, v12
  v_xor_b32 v9, v9, v12
  v_and_b32 v12, 0x40, v0
  v_lshlrev_b32 v12, 4, v12
  v_xor_b32 v9, v9, v12
  v_and_b32 v12, 0x2, v0
  v_lshlrev_b32 v12, 5, v12
  v_xor_b32 v9, v9, v12
  v_and_b32 v10, 0x1f, v0
  v_lshlrev_b32 v10, 2, v10
  v_and_b32 v12, 0x20, v0
  v_lshlrev_b32 v12, 6, v12
  v_xor_b32 v10, v10, v12
  v_and_b32 v12, 0x80, v0
  v_lshlrev_b32 v12, 22, v12
  v_xor_b32 v10, v10, v12
  v_bfe_i32 v12, v0, 1, 1
  v_and_b32 v12, 0xaaaa, v12
  v_or_b32 v11, 0x4444, v12
  v_and_b32 v12, 3, v2
  v_mov_b32 v16, 0x3f80
  v_mov_b32 v17, 0x3f800000
  v_cmp_eq_u32 vcc, 1, v12
  s_nop 1
  v_cndmask_b32 v16, v16, v17, vcc
  v_mov_b32 v17, 0x3f803f80
  v_cmp_le_u32 vcc, 2, v12
  s_nop 1
  v_cndmask_b32 v16, v16, v17, vcc
  v_mov_b32 v17, v16
  v_mov_b32 v18, v16
  v_mov_b32 v19, v16
  v_mov_b32 v12, v16
  v_mov_b32 v13, 0
  v_and_b32 v32, 0x30, v0
  v_lshrrev_b32 v32, 1, v32
  v_and_b32 v14, 0xc0, v0
  v_lshlrev_b32 v14, 2, v14
  v_xor_b32 v32, v32, v14
  v_and_b32 v14, 0x2, v0
  v_lshlrev_b32 v14, 5, v14
  v_xor_b32 v32, v32, v14
  v_and_b32 v14, 0xc, v0
  v_lshlrev_b32 v14, 9, v14
  v_xor_b32 v32, v32, v14
  v_and_b32 v14, 0x1, v0
  v_lshlrev_b32 v14, 10, v14
  v_xor_b32 v32, v32, v14
  v_and_b32 v33, 0x3f, v0
  v_lshlrev_b32 v33, 4, v33
  v_and_b32 v14, 0xc0, v0
  v_lshlrev_b32 v14, 6, v14
  v_xor_b32 v33, v33, v14
  v_add_u32 v34, 0x10000, v33
  v_add_u32 v35, 0x20000, v33
  v_lshlrev_b32 v36, 2, v2
  v_add_u32 v0, 0x8000, v33
  v_add_u32 v2, 0x18000, v33
  s_and_b32 s10, s4, 1
  s_lshl_b32 s10, s10, 14
  v_add_u32 v44, s10, v26
  v_add_u32 v45, s10, v27
  v_xor_b32 v46, 0x4000, v44
  v_xor_b32 v47, 0x4000, v45
  v_add_u32 v48, s10, v28
  v_add_u32 v49, s10, v29
  v_xor_b32 v50, 0x4000, v48
  v_xor_b32 v51, 0x4000, v49
  v_add_u32 v52, s10, v30
  v_add_u32 v53, s10, v31
  v_xor_b32 v54, 0x4000, v52
  v_xor_b32 v55, 0x4000, v53
  s_waitcnt vmcnt(8)
  s_barrier
  ds_read_b64_tr_b16 a[0:1], v52 offset:0
  ds_read_b64_tr_b16 a[2:3], v52 offset:1024
  ds_read_b64_tr_b16 a[4:5], v52 offset:8192
  ds_read_b64_tr_b16 a[6:7], v52 offset:9216
  ds_read_b64_tr_b16 a[8:9], v53 offset:0
  ds_read_b64_tr_b16 a[10:11], v53 offset:1024
  ds_read_b64_tr_b16 a[12:13], v53 offset:8192
  ds_read_b64_tr_b16 a[14:15], v53 offset:9216
  ds_read_b64_tr_b16 a[32:33], v54 offset:0
  ds_read_b64_tr_b16 a[34:35], v54 offset:1024
  ds_read_b64_tr_b16 a[36:37], v54 offset:8192
  ds_read_b64_tr_b16 a[38:39], v54 offset:9216
  ds_read_b64_tr_b16 a[40:41], v55 offset:0
  ds_read_b64_tr_b16 a[42:43], v55 offset:1024
  ds_read_b64_tr_b16 a[44:45], v55 offset:8192
  ds_read_b64_tr_b16 a[46:47], v55 offset:9216
  s_waitcnt lgkmcnt(0)
  s_barrier
  s_add_u32 m0, s88, 0x8000
  s_add_u32 s10, s90, 0x0
  buffer_load_dwordx4 v40, s[48:51], s10 offen lds
  s_add_u32 m0, s88, 0x8400
  s_add_u32 s10, s90, 0x2000
  buffer_load_dwordx4 v40, s[48:51], s10 offen lds
  s_add_u32 m0, s88, 0x8800
  s_add_u32 s10, s90, 0x8000
  buffer_load_dwordx4 v40, s[48:51], s10 offen lds
  s_add_u32 m0, s88, 0x8c00
  s_add_u32 s10, s90, 0xa000
  buffer_load_dwordx4 v40, s[48:51], s10 offen lds
  s_add_u32 m0, s88, 0xc000
  s_add_u32 s10, s90, 0x0
  buffer_load_dwordx4 v41, s[48:51], s10 offen lds
  s_add_u32 m0, s88, 0xc400
  s_add_u32 s10, s90, 0x2000
  buffer_load_dwordx4 v41, s[48:51], s10 offen lds
  s_add_u32 m0, s88, 0xc800
  s_add_u32 s10, s90, 0x8000
  buffer_load_dwordx4 v41, s[48:51], s10 offen lds
  s_add_u32 m0, s88, 0xcc00
  s_add_u32 s10, s90, 0xa000
  buffer_load_dwordx4 v41, s[48:51], s10 offen lds
  s_waitcnt vmcnt(8)
  s_barrier
  ds_read_b64_tr_b16 a[16:17], v44 offset:0
  ds_read_b64_tr_b16 a[18:19], v44 offset:1024
  ds_read_b64_tr_b16 a[20:21], v44 offset:8192
  ds_read_b64_tr_b16 a[22:23], v44 offset:9216
  ds_read_b64_tr_b16 a[24:25], v45 offset:0
  ds_read_b64_tr_b16 a[26:27], v45 offset:1024
  ds_read_b64_tr_b16 a[28:29], v45 offset:8192
  ds_read_b64_tr_b16 a[30:31], v45 offset:9216
  ds_read_b64_tr_b16 a[48:49], v46 offset:0
  ds_read_b64_tr_b16 a[50:51], v46 offset:1024
  ds_read_b64_tr_b16 a[52:53], v46 offset:8192
  ds_read_b64_tr_b16 a[54:55], v46 offset:9216
  ds_read_b64_tr_b16 a[56:57], v47 offset:0
  ds_read_b64_tr_b16 a[58:59], v47 offset:1024
  ds_read_b64_tr_b16 a[60:61], v47 offset:8192
  ds_read_b64_tr_b16 a[62:63], v47 offset:9216
  s_waitcnt lgkmcnt(0)
  s_barrier
  s_add_u32 m0, s88, 0x10000
  s_add_u32 s10, s90, 0x80000
  buffer_load_dwordx4 v40, s[48:51], s10 offen lds
  s_add_u32 m0, s88, 0x10400
  s_add_u32 s10, s90, 0x82000
  buffer_load_dwordx4 v40, s[48:51], s10 offen lds
  s_add_u32 m0, s88, 0x10800
  s_add_u32 s10, s90, 0x88000
  buffer_load_dwordx4 v40, s[48:51], s10 offen lds
  s_add_u32 m0, s88, 0x10c00
  s_add_u32 s10, s90, 0x8a000
  buffer_load_dwordx4 v40, s[48:51], s10 offen lds
  s_add_u32 m0, s88, 0x14000
  s_add_u32 s10, s90, 0x80000
  buffer_load_dwordx4 v41, s[48:51], s10 offen lds
  s_add_u32 m0, s88, 0x14400
  s_add_u32 s10, s90, 0x82000
  buffer_load_dwordx4 v41, s[48:51], s10 offen lds
  s_add_u32 m0, s88, 0x14800
  s_add_u32 s10, s90, 0x88000
  buffer_load_dwordx4 v41, s[48:51], s10 offen lds
  s_add_u32 m0, s88, 0x14c00
  s_add_u32 s10, s90, 0x8a000
  buffer_load_dwordx4 v41, s[48:51], s10 offen lds
  s_waitcnt vmcnt(8)
  s_barrier
  s_buffer_load_dword s16, s[68:71], 132
  ds_read_b64_tr_b16 a[64:65], v44 offset:32768
  ds_read_b64_tr_b16 a[66:67], v44 offset:33792
  ds_read_b64_tr_b16 a[68:69], v44 offset:40960
  ds_read_b64_tr_b16 a[70:71], v44 offset:41984
  ds_read_b64_tr_b16 a[72:73], v45 offset:32768
  ds_read_b64_tr_b16 a[74:75], v45 offset:33792
  ds_read_b64_tr_b16 a[76:77], v45 offset:40960
  ds_read_b64_tr_b16 a[78:79], v45 offset:41984
  ds_read_b64_tr_b16 a[96:97], v46 offset:32768
  ds_read_b64_tr_b16 a[98:99], v46 offset:33792
  ds_read_b64_tr_b16 a[100:101], v46 offset:40960
  ds_read_b64_tr_b16 a[102:103], v46 offset:41984
  ds_read_b64_tr_b16 a[104:105], v47 offset:32768
  ds_read_b64_tr_b16 a[106:107], v47 offset:33792
  ds_read_b64_tr_b16 a[108:109], v47 offset:40960
  ds_read_b64_tr_b16 a[110:111], v47 offset:41984
  s_waitcnt lgkmcnt(0)
  s_cmp_eq_u32 s16, s95
  s_cbranch_scc1 L_sure_1
  s_mov_b32 s14, 0
L_rdy_2:
  buffer_load_dword v4, off, s[68:71], 0 offset:132 sc1
  s_add_u32 s14, s14, 1
  s_cmp_gt_u32 s14, 200000
  s_cbranch_scc1 L_end
  s_waitcnt vmcnt(0)
  v_readfirstlane_b32 s10, v4
  s_nop 0
  s_cmp_eq_u32 s10, 0
  s_cbranch_scc1 L_rdy_2
  s_cmp_lg_u32 s10, s95
  s_cbranch_scc1 L_restart
L_sure_1:
  v_mov_b64 v[60:61], -1
  v_mov_b64 v[62:63], -1
  s_lshl_b32 s16, s5, 13
  s_add_u32 s16, s16, s78
  s_add_u32 s16, s16, 0x80000
  s_add_u32 s17, s16, 0x40000
  s_lshl_b32 s18, s4, 13
  s_lshl_b32 s10, s5, 8
  s_add_u32 s18, s18, s10
  s_add_u32 s18, s18, 0x10000
  v_lshlrev_b32 v15, 6, v36
  buffer_store_dwordx4 v[60:63], v1, s[72:75], s16 offen sc1
  buffer_store_dwordx4 v[60:63], v1, s[72:75], s16 offen offset:1024 sc1
  buffer_store_dwordx4 v[60:63], v1, s[72:75], s17 offen sc1
  buffer_store_dwordx4 v[60:63], v1, s[72:75], s17 offen offset:1024 sc1
  buffer_store_dword v60, v36, s[72:75], s18 offen sc1
  s_and_b32 exec_lo, s32, 255
  s_mov_b32 exec_hi, 0
  buffer_store_dword v60, v15, s[72:75], s34 offen sc1
  buffer_store_dword v60, v15, s[72:75], s34 offen offset:128 sc1
  buffer_store_dword v60, v15, s[72:75], s34 offen offset:2048 sc1
  s_mov_b64 exec, -1
  s_barrier
  s_add_u32 m0, s88, 0x18000
  s_add_u32 s10, s90, 0x0
  buffer_load_dwordx4 v38, s[44:47], s10 offen lds
  s_add_u32 m0, s88, 0x18400
  s_add_u32 s10, s90, 0x2000
  buffer_load_dwordx4 v38, s[44:47], s10 offen lds
  s_add_u32 m0, s88, 0x18800
  s_add_u32 s10, s90, 0x8000
  buffer_load_dwordx4 v38, s[44:47], s10 offen lds
  s_add_u32 m0, s88, 0x18c00
  s_add_u32 s10, s90, 0xa000
  buffer_load_dwordx4 v38, s[44:47], s10 offen lds
  s_add_u32 m0, s88, 0x1c000
  s_add_u32 s10, s90, 0x0
  buffer_load_dwordx4 v39, s[44:47], s10 offen lds
  s_add_u32 m0, s88, 0x1c400
  s_add_u32 s10, s90, 0x2000
  buffer_load_dwordx4 v39, s[44:47], s10 offen lds
  s_add_u32 m0, s88, 0x1c800
  s_add_u32 s10, s90, 0x8000
  buffer_load_dwordx4 v39, s[44:47], s10 offen lds
  s_add_u32 m0, s88, 0x1cc00
  s_add_u32 s10, s90, 0xa000
  buffer_load_dwordx4 v39, s[44:47], s10 offen lds
  s_waitcnt vmcnt(16)
  s_barrier
  ds_read_b64_tr_b16 a[80:81], v48 offset:0
  ds_read_b64_tr_b16 a[82:83], v48 offset:1024
  ds_read_b64_tr_b16 a[84:85], v48 offset:8192
  ds_read_b64_tr_b16 a[86:87], v48 offset:9216
  ds_read_b64_tr_b16 a[88:89], v49 offset:0
  ds_read_b64_tr_b16 a[90:91], v49 offset:1024
  ds_read_b64_tr_b16 a[92:93], v49 offset:8192
  ds_read_b64_tr_b16 a[94:95], v49 offset:9216
  ds_read_b64_tr_b16 a[112:113], v50 offset:0
  ds_read_b64_tr_b16 a[114:115], v50 offset:1024
  ds_read_b64_tr_b16 a[116:117], v50 offset:8192
  ds_read_b64_tr_b16 a[118:119], v50 offset:9216
  ds_read_b64_tr_b16 a[120:121], v51 offset:0
  ds_read_b64_tr_b16 a[122:123], v51 offset:1024
  ds_read_b64_tr_b16 a[124:125], v51 offset:8192
  ds_read_b64_tr_b16 a[126:127], v51 offset:9216
  s_waitcnt lgkmcnt(0)
  s_barrier
  s_add_u32 m0, s88, 0x20000
  s_add_u32 s10, s90, 0x80000
  buffer_load_dwordx4 v38, s[44:47], s10 offen lds
  s_add_u32 m0, s88, 0x20400
  s_add_u32 s10, s90, 0x82000
  buffer_load_dwordx4 v38, s[44:47], s10 offen lds
  s_add_u32 m0, s88, 0x20800
  s_add_u32 s10, s90, 0x88000
  buffer_load_dwordx4 v38, s[44:47], s10 offen lds
  s_add_u32 m0, s88, 0x20c00
  s_add_u32 s10, s90, 0x8a000
  buffer_load_dwordx4 v38, s[44:47], s10 offen lds
  s_add_u32 m0, s88, 0x24000
  s_add_u32 s10, s90, 0x80000
  buffer_load_dwordx4 v39, s[44:47], s10 offen lds
  s_add_u32 m0, s88, 0x24400
  s_add_u32 s10, s90, 0x82000
  buffer_load_dwordx4 v39, s[44:47], s10 offen lds
  s_add_u32 m0, s88, 0x24800
  s_add_u32 s10, s90, 0x88000
  buffer_load_dwordx4 v39, s[44:47], s10 offen lds
  s_add_u32 m0, s88, 0x24c00
  s_add_u32 s10, s90, 0x8a000
  buffer_load_dwordx4 v39, s[44:47], s10 offen lds
  s_waitcnt vmcnt(8)
  s_barrier
  s_getreg_b32 s10, hwreg(HW_REG_XCC_ID)
  s_and_b32 s10, s10, 15
  s_add_u32 s10, s10, 1
  v_mov_b32 v15, s10
  s_lshl_b32 s10, s5, 2
  s_cmp_eq_u32 s4, 0
  s_cselect_b64 exec, 1, 0
  buffer_store_dword v15, off, s[68:71], s10 sc1
  s_mov_b64 exec, -1
  ds_read_b64_tr_b16 a[128:129], v48 offset:32768
  ds_read_b64_tr_b16 a[130:131], v48 offset:33792
  ds_read_b64_tr_b16 a[132:133], v48 offset:40960
  ds_read_b64_tr_b16 a[134:135], v48 offset:41984
  ds_read_b64_tr_b16 a[136:137], v49 offset:32768
  ds_read_b64_tr_b16 a[138:139], v49 offset:33792
  ds_read_b64_tr_b16 a[140:141], v49 offset:40960
  ds_read_b64_tr_b16 a[142:143], v49 offset:41984
  ds_read_b64_tr_b16 a[160:161], v50 offset:32768
  ds_read_b64_tr_b16 a[162:163], v50 offset:33792
  ds_read_b64_tr_b16 a[164:165], v50 offset:40960
  ds_read_b64_tr_b16 a[166:167], v50 offset:41984
  ds_read_b64_tr_b16 a[168:169], v51 offset:32768
  ds_read_b64_tr_b16 a[170:171], v51 offset:33792
  ds_read_b64_tr_b16 a[172:173], v51 offset:40960
  ds_read_b64_tr_b16 a[174:175], v51 offset:41984
  s_waitcnt lgkmcnt(0)
  s_barrier
  s_add_u32 m0, s88, 0x0
  s_add_u32 s10, s90, 0x0
  buffer_load_dwordx4 v40, s[40:43], s10 offen lds
  s_add_u32 m0, s88, 0x400
  s_add_u32 s10, s90, 0x2000
  buffer_load_dwordx4 v40, s[40:43], s10 offen lds
  s_add_u32 m0, s88, 0x800
  s_add_u32 s10, s90, 0x8000
  buffer_load_dwordx4 v40, s[40:43], s10 offen lds
  s_add_u32 m0, s88, 0xc00
  s_add_u32 s10, s90, 0xa000
  buffer_load_dwordx4 v40, s[40:43], s10 offen lds
  s_add_u32 m0, s88, 0x4000
  s_add_u32 s10, s90, 0x0
  buffer_load_dwordx4 v41, s[40:43], s10 offen lds
  s_add_u32 m0, s88, 0x4400
  s_add_u32 s10, s90, 0x2000
  buffer_load_dwordx4 v41, s[40:43], s10 offen lds
  s_add_u32 m0, s88, 0x4800
  s_add_u32 s10, s90, 0x8000
  buffer_load_dwordx4 v41, s[40:43], s10 offen lds
  s_add_u32 m0, s88, 0x4c00
  s_add_u32 s10, s90, 0xa000
  buffer_load_dwordx4 v41, s[40:43], s10 offen lds
  s_waitcnt vmcnt(9)
  s_barrier
  ds_read_b64_tr_b16 a[144:145], v52 offset:0
  ds_read_b64_tr_b16 a[146:147], v52 offset:1024
  ds_read_b64_tr_b16 a[148:149], v52 offset:8192
  ds_read_b64_tr_b16 a[150:151], v52 offset:9216
  ds_read_b64_tr_b16 a[152:153], v53 offset:0
  ds_read_b64_tr_b16 a[154:155], v53 offset:1024
  ds_read_b64_tr_b16 a[156:157], v53 offset:8192
  ds_read_b64_tr_b16 a[158:159], v53 offset:9216
  ds_read_b64_tr_b16 a[176:177], v54 offset:0
  ds_read_b64_tr_b16 a[178:179], v54 offset:1024
  ds_read_b64_tr_b16 a[180:181], v54 offset:8192
  ds_read_b64_tr_b16 a[182:183], v54 offset:9216
  ds_read_b64_tr_b16 a[184:185], v55 offset:0
  ds_read_b64_tr_b16 a[186:187], v55 offset:1024
  ds_read_b64_tr_b16 a[188:189], v55 offset:8192
  ds_read_b64_tr_b16 a[190:191], v55 offset:9216
  s_waitcnt lgkmcnt(0)
  s_barrier
  s_add_u32 m0, s88, 0x8000
  s_add_u32 s10, s90, 0x80000
  buffer_load_dwordx4 v40, s[40:43], s10 offen lds
  s_add_u32 m0, s88, 0x8400
  s_add_u32 s10, s90, 0x82000
  buffer_load_dwordx4 v40, s[40:43], s10 offen lds
  s_add_u32 m0, s88, 0x8800
  s_add_u32 s10, s90, 0x88000
  buffer_load_dwordx4 v40, s[40:43], s10 offen lds
  s_add_u32 m0, s88, 0x8c00
  s_add_u32 s10, s90, 0x8a000
  buffer_load_dwordx4 v40, s[40:43], s10 offen lds
  s_add_u32 m0, s88, 0xc000
  s_add_u32 s10, s90, 0x80000
  buffer_load_dwordx4 v41, s[40:43], s10 offen lds
  s_add_u32 m0, s88, 0xc400
  s_add_u32 s10, s90, 0x82000
  buffer_load_dwordx4 v41, s[40:43], s10 offen lds
  s_add_u32 m0, s88, 0xc800
  s_add_u32 s10, s90, 0x88000
  buffer_load_dwordx4 v41, s[40:43], s10 offen lds
  s_add_u32 m0, s88, 0xcc00
  s_add_u32 s10, s90, 0x8a000
  buffer_load_dwordx4 v41, s[40:43], s10 offen lds
  buffer_load_dwordx2 v[28:29], v32, s[36:39], 0 offen offset:0
  buffer_load_dwordx2 v[30:31], v32, s[36:39], 0 offen offset:32
  buffer_load_dwordx2 v[20:21], v32, s[36:39], 0 offen offset:128
  buffer_load_dwordx2 v[22:23], v32, s[36:39], 0 offen offset:160
  v_mov_b32 v32, v42
  s_waitcnt vmcnt(12)
  s_barrier
  ds_read_b64_tr_b16 a[240:241], v44 offset:0
  ds_read_b64_tr_b16 a[242:243], v44 offset:1024
  ds_read_b64_tr_b16 a[244:245], v44 offset:8192
  ds_read_b64_tr_b16 a[246:247], v44 offset:9216
  ds_read_b64_tr_b16 a[248:249], v45 offset:0
  ds_read_b64_tr_b16 a[250:251], v45 offset:1024
  ds_read_b64_tr_b16 a[252:253], v45 offset:8192
  ds_read_b64_tr_b16 a[254:255], v45 offset:9216
  ds_read_b64_tr_b16 v[144:145], v46 offset:0
  ds_read_b64_tr_b16 v[146:147], v46 offset:1024
  ds_read_b64_tr_b16 v[148:149], v46 offset:8192
  ds_read_b64_tr_b16 v[150:151], v46 offset:9216
  ds_read_b64_tr_b16 v[152:153], v47 offset:0
  ds_read_b64_tr_b16 v[154:155], v47 offset:1024
  ds_read_b64_tr_b16 v[156:157], v47 offset:8192
  ds_read_b64_tr_b16 v[158:159], v47 offset:9216
  s_waitcnt lgkmcnt(0)
  s_barrier
  s_add_u32 m0, s88, 0x10000
  s_add_u32 s10, s89, 0x0
  buffer_load_dwordx4 v25, s[52:55], s10 offen lds
  s_add_u32 m0, s88, 0x10400
  s_add_u32 s10, s89, 0x2000
  buffer_load_dwordx4 v25, s[52:55], s10 offen lds
  s_add_u32 m0, s88, 0x10800
  s_add_u32 s10, s89, 0x1000
  buffer_load_dwordx4 v25, s[52:55], s10 offen lds
  s_add_u32 m0, s88, 0x10c00
  s_add_u32 s10, s89, 0x3000
  buffer_load_dwordx4 v25, s[52:55], s10 offen lds
  s_add_u32 m0, s88, 0x14000
  s_add_u32 s10, s89, 0x40
  buffer_load_dwordx4 v25, s[52:55], s10 offen lds
  s_add_u32 m0, s88, 0x14400
  s_add_u32 s10, s89, 0x2040
  buffer_load_dwordx4 v25, s[52:55], s10 offen lds
  s_add_u32 m0, s88, 0x14800
  s_add_u32 s10, s89, 0x1040
  buffer_load_dwordx4 v25, s[52:55], s10 offen lds
  s_add_u32 m0, s88, 0x14c00
  s_add_u32 s10, s89, 0x3040
  buffer_load_dwordx4 v25, s[52:55], s10 offen lds
  s_waitcnt vmcnt(12)
  s_barrier
  ds_read_b64_tr_b16 v[128:129], v44 offset:32768
  ds_read_b64_tr_b16 v[130:131], v44 offset:33792
  ds_read_b64_tr_b16 v[132:133], v44 offset:40960
  ds_read_b64_tr_b16 v[134:135], v44 offset:41984
  ds_read_b64_tr_b16 v[136:137], v45 offset:32768
  ds_read_b64_tr_b16 v[138:139], v45 offset:33792
  ds_read_b64_tr_b16 v[140:141], v45 offset:40960
  ds_read_b64_tr_b16 v[142:143], v45 offset:41984
  ds_read_b64_tr_b16 v[160:161], v46 offset:32768
  ds_read_b64_tr_b16 v[162:163], v46 offset:33792
  ds_read_b64_tr_b16 v[164:165], v46 offset:40960
  ds_read_b64_tr_b16 v[166:167], v46 offset:41984
  ds_read_b64_tr_b16 v[168:169], v47 offset:32768
  ds_read_b64_tr_b16 v[170:171], v47 offset:33792
  ds_read_b64_tr_b16 v[172:173], v47 offset:40960
  ds_read_b64_tr_b16 v[174:175], v47 offset:41984
  s_waitcnt lgkmcnt(0)
  s_barrier
  s_add_u32 m0, s88, 0x18000
  s_add_u32 s10, s89, 0x80
  buffer_load_dwordx4 v25, s[52:55], s10 offen lds
  s_add_u32 m0, s88, 0x18400
  s_add_u32 s10, s89, 0x2080
  buffer_load_dwordx4 v25, s[52:55], s10 offen lds
  s_add_u32 m0, s88, 0x18800
  s_add_u32 s10, s89, 0x1080
  buffer_load_dwordx4 v25, s[52:55], s10 offen lds
  s_add_u32 m0, s88, 0x18c00
  s_add_u32 s10, s89, 0x3080
  buffer_load_dwordx4 v25, s[52:55], s10 offen lds
  s_add_u32 m0, s88, 0x1c000
  s_add_u32 s10, s89, 0xc0
  buffer_load_dwordx4 v25, s[52:55], s10 offen lds
  s_add_u32 m0, s88, 0x1c400
  s_add_u32 s10, s89, 0x20c0
  buffer_load_dwordx4 v25, s[52:55], s10 offen lds
  s_add_u32 m0, s88, 0x1c800
  s_add_u32 s10, s89, 0x10c0
  buffer_load_dwordx4 v25, s[52:55], s10 offen lds
  s_add_u32 m0, s88, 0x1cc00
  s_add_u32 s10, s89, 0x30c0
  buffer_load_dwordx4 v25, s[52:55], s10 offen lds
  s_waitcnt vmcnt(8)
  s_barrier
  v_add_u32 v60, 0x10000, v56
  v_add_u32 v61, 0x10000, v57
  v_add_u32 v62, 0x10000, v58
  v_add_u32 v63, 0x10000, v59
  ds_read_b64_tr_b16 v[176:177], v60 offset:0
  ds_read_b64_tr_b16 v[178:179], v61 offset:512
  ds_read_b64_tr_b16 v[180:181], v60 offset:1024
  ds_read_b64_tr_b16 v[182:183], v61 offset:1536
  ds_read_b64_tr_b16 v[184:185], v62 offset:0
  ds_read_b64_tr_b16 v[186:187], v63 offset:512
  ds_read_b64_tr_b16 v[188:189], v62 offset:1024
  ds_read_b64_tr_b16 v[190:191], v63 offset:1536
  v_add_u32 v60, 0x10000, v56
  v_add_u32 v61, 0x10000, v57
  v_add_u32 v62, 0x10000, v58
  v_add_u32 v63, 0x10000, v59
  ds_read_b64_tr_b16 v[192:193], v60 offset:16384
  ds_read_b64_tr_b16 v[194:195], v61 offset:16896
  ds_read_b64_tr_b16 v[196:197], v60 offset:17408
  ds_read_b64_tr_b16 v[198:199], v61 offset:17920
  ds_read_b64_tr_b16 v[200:201], v62 offset:16384
  ds_read_b64_tr_b16 v[202:203], v63 offset:16896
  ds_read_b64_tr_b16 v[204:205], v62 offset:17408
  ds_read_b64_tr_b16 v[206:207], v63 offset:17920
  s_waitcnt lgkmcnt(0)
  s_barrier
  s_add_u32 m0, s88, 0x20000
  s_add_u32 s10, s90, 0x80000
  buffer_load_dwordx4 v38, s[40:43], s10 offen lds
  s_add_u32 m0, s88, 0x20400
  s_add_u32 s10, s90, 0x82000
  buffer_load_dwordx4 v38, s[40:43], s10 offen lds
  s_add_u32 m0, s88, 0x20800
  s_add_u32 s10, s90, 0x88000
  buffer_load_dwordx4 v38, s[40:43], s10 offen lds
  s_add_u32 m0, s88, 0x20c00
  s_add_u32 s10, s90, 0x8a000
  buffer_load_dwordx4 v38, s[40:43], s10 offen lds
  s_add_u32 m0, s88, 0x24000
  s_add_u32 s10, s90, 0x80000
  buffer_load_dwordx4 v39, s[40:43], s10 offen lds
  s_add_u32 m0, s88, 0x24400
  s_add_u32 s10, s90, 0x82000
  buffer_load_dwordx4 v39, s[40:43], s10 offen lds
  s_add_u32 m0, s88, 0x24800
  s_add_u32 s10, s90, 0x88000
  buffer_load_dwordx4 v39, s[40:43], s10 offen lds
  s_add_u32 m0, s88, 0x24c00
  s_add_u32 s10, s90, 0x8a000
  buffer_load_dwordx4 v39, s[40:43], s10 offen lds
  s_waitcnt vmcnt(8)
  s_barrier
  v_add_u32 v60, 0x10000, v56
  v_add_u32 v61, 0x10000, v57
  v_add_u32 v62, 0x10000, v58
  v_add_u32 v63, 0x10000, v59
  ds_read_b64_tr_b16 v[208:209], v60 offset:32768
  ds_read_b64_tr_b16 v[210:211], v61 offset:33280
  ds_read_b64_tr_b16 v[212:213], v60 offset:33792
  ds_read_b64_tr_b16 v[214:215], v61 offset:34304
  ds_read_b64_tr_b16 v[216:217], v62 offset:32768
  ds_read_b64_tr_b16 v[218:219], v63 offset:33280
  ds_read_b64_tr_b16 v[220:221], v62 offset:33792
  ds_read_b64_tr_b16 v[222:223], v63 offset:34304
  v_add_u32 v60, 0x10000, v56
  v_add_u32 v61, 0x10000, v57
  v_add_u32 v62, 0x10000, v58
  v_add_u32 v63, 0x10000, v59
  ds_read_b64_tr_b16 v[224:225], v60 offset:49152
  ds_read_b64_tr_b16 v[226:227], v61 offset:49664
  ds_read_b64_tr_b16 v[228:229], v60 offset:50176
  ds_read_b64_tr_b16 v[230:231], v61 offset:50688
  ds_read_b64_tr_b16 v[232:233], v62 offset:49152
  ds_read_b64_tr_b16 v[234:235], v63 offset:49664
  ds_read_b64_tr_b16 v[236:237], v62 offset:50176
  ds_read_b64_tr_b16 v[238:239], v63 offset:50688
  s_waitcnt lgkmcnt(0)
  s_barrier
  buffer_load_dword v14, off, s[68:71], 0 offset:128 sc1
  s_add_u32 m0, s88, 0x0
  s_add_u32 s10, s90, 0x0
  buffer_load_dwordx4 v40, s[44:47], s10 offen lds
  s_add_u32 m0, s88, 0x400
  s_add_u32 s10, s90, 0x2000
  buffer_load_dwordx4 v40, s[44:47], s10 offen lds
  s_add_u32 m0, s88, 0x800
  s_add_u32 s10, s90, 0x8000
  buffer_load_dwordx4 v40, s[44:47], s10 offen lds
  s_add_u32 m0, s88, 0xc00
  s_add_u32 s10, s90, 0xa000
  buffer_load_dwordx4 v40, s[44:47], s10 offen lds
  s_add_u32 m0, s88, 0x4000
  s_add_u32 s10, s90, 0x0
  buffer_load_dwordx4 v41, s[44:47], s10 offen lds
  s_add_u32 m0, s88, 0x4400
  s_add_u32 s10, s90, 0x2000
  buffer_load_dwordx4 v41, s[44:47], s10 offen lds
  s_add_u32 m0, s88, 0x4800
  s_add_u32 s10, s90, 0x8000
  buffer_load_dwordx4 v41, s[44:47], s10 offen lds
  s_add_u32 m0, s88, 0x4c00
  s_add_u32 s10, s90, 0xa000
  buffer_load_dwordx4 v41, s[44:47], s10 offen lds
  s_waitcnt vmcnt(9)
  s_barrier
  ds_read_b64_tr_b16 v[112:113], v52 offset:0
  ds_read_b64_tr_b16 v[114:115], v52 offset:1024
  ds_read_b64_tr_b16 v[116:117], v52 offset:8192
  ds_read_b64_tr_b16 v[118:119], v52 offset:9216
  ds_read_b64_tr_b16 v[120:121], v53 offset:0
  ds_read_b64_tr_b16 v[122:123], v53 offset:1024
  ds_read_b64_tr_b16 v[124:125], v53 offset:8192
  ds_read_b64_tr_b16 v[126:127], v53 offset:9216
  ds_read_b64_tr_b16 a[224:225], v54 offset:0
  ds_read_b64_tr_b16 a[226:227], v54 offset:1024
  ds_read_b64_tr_b16 a[228:229], v54 offset:8192
  ds_read_b64_tr_b16 a[230:231], v54 offset:9216
  ds_read_b64_tr_b16 a[232:233], v55 offset:0
  ds_read_b64_tr_b16 a[234:235], v55 offset:1024
  ds_read_b64_tr_b16 a[236:237], v55 offset:8192
  ds_read_b64_tr_b16 a[238:239], v55 offset:9216
  s_waitcnt lgkmcnt(0)
  s_barrier
  s_add_u32 m0, s88, 0x8000
  s_add_u32 s10, s90, 0x80000
  buffer_load_dwordx4 v40, s[44:47], s10 offen lds
  s_add_u32 m0, s88, 0x8400
  s_add_u32 s10, s90, 0x82000
  buffer_load_dwordx4 v40, s[44:47], s10 offen lds
  s_add_u32 m0, s88, 0x8800
  s_add_u32 s10, s90, 0x88000
  buffer_load_dwordx4 v40, s[44:47], s10 offen lds
  s_add_u32 m0, s88, 0x8c00
  s_add_u32 s10, s90, 0x8a000
  buffer_load_dwordx4 v40, s[44:47], s10 offen lds
  s_add_u32 m0, s88, 0xc000
  s_add_u32 s10, s90, 0x80000
  buffer_load_dwordx4 v41, s[44:47], s10 offen lds
  s_add_u32 m0, s88, 0xc400
  s_add_u32 s10, s90, 0x82000
  buffer_load_dwordx4 v41, s[44:47], s10 offen lds
  s_add_u32 m0, s88, 0xc800
  s_add_u32 s10, s90, 0x88000
  buffer_load_dwordx4 v41, s[44:47], s10 offen lds
  s_add_u32 m0, s88, 0xcc00
  s_add_u32 s10, s90, 0x8a000
  buffer_load_dwordx4 v41, s[44:47], s10 offen lds
  s_waitcnt vmcnt(8)
  v_readfirstlane_b32 s10, v14
  s_nop 0
  s_cmp_eq_u32 s10, s95
  s_cbranch_scc1 L_sure_3
  s_mov_b32 s14, 0
L_rdy_4:
  buffer_load_dword v4, off, s[68:71], 0 offset:128 sc1
  s_add_u32 s14, s14, 1
  s_cmp_gt_u32 s14, 200000
  s_cbranch_scc1 L_end
  s_waitcnt vmcnt(0)
  v_readfirstlane_b32 s10, v4
  s_nop 0
  s_cmp_eq_u32 s10, 0
  s_cbranch_scc1 L_rdy_4
  s_cmp_lg_u32 s10, s95
  s_cbranch_scc1 L_restart
L_sure_3:
  s_barrier
  ds_read_b64_tr_b16 a[192:193], v44 offset:0
  ds_read_b64_tr_b16 a[194:195], v44 offset:1024
  ds_read_b64_tr_b16 a[196:197], v44 offset:8192
  ds_read_b64_tr_b16 a[198:199], v44 offset:9216
  ds_read_b64_tr_b16 a[200:201], v45 offset:0
  ds_read_b64_tr_b16 a[202:203], v45 offset:1024
  ds_read_b64_tr_b16 a[204:205], v45 offset:8192
  ds_read_b64_tr_b16 a[206:207], v45 offset:9216
  ds_read_b64_tr_b16 v[96:97], v46 offset:0
  ds_read_b64_tr_b16 v[98:99], v46 offset:1024
  ds_read_b64_tr_b16 v[100:101], v46 offset:8192
  ds_read_b64_tr_b16 v[102:103], v46 offset:9216
  ds_read_b64_tr_b16 v[104:105], v47 offset:0
  ds_read_b64_tr_b16 v[106:107], v47 offset:1024
  ds_read_b64_tr_b16 v[108:109], v47 offset:8192
  ds_read_b64_tr_b16 v[110:111], v47 offset:9216
  s_waitcnt lgkmcnt(0)
  s_barrier
  s_add_u32 s13, s13, 12288
  v_and_b32 v41, 16, v1
  v_lshlrev_b32 v41, 3, v41
  buffer_load_dword v40, v41, s[72:75], s13 offen sc1
  s_add_u32 m0, s88, 0x10000
  s_add_u32 s10, s89, 0x0
  buffer_load_dwordx4 v32, s[52:55], s10 offen lds
  s_add_u32 m0, s88, 0x10400
  s_add_u32 s10, s89, 0x2000
  buffer_load_dwordx4 v32, s[52:55], s10 offen lds
  s_add_u32 m0, s88, 0x10800
  s_add_u32 s10, s89, 0x1000
  buffer_load_dwordx4 v32, s[52:55], s10 offen lds
  s_add_u32 m0, s88, 0x10c00
  s_add_u32 s10, s89, 0x3000
  buffer_load_dwordx4 v32, s[52:55], s10 offen lds
  s_add_u32 m0, s88, 0x14000
  s_add_u32 s10, s89, 0x40
  buffer_load_dwordx4 v32, s[52:55], s10 offen lds
  s_add_u32 m0, s88, 0x14400
  s_add_u32 s10, s89, 0x2040
  buffer_load_dwordx4 v32, s[52:55], s10 offen lds
  s_add_u32 m0, s88, 0x14800
  s_add_u32 s10, s89, 0x1040
  buffer_load_dwordx4 v32, s[52:55], s10 offen lds
  s_add_u32 m0, s88, 0x14c00
  s_add_u32 s10, s89, 0x3040
  buffer_load_dwordx4 v32, s[52:55], s10 offen lds
  s_waitcnt vmcnt(9)
  s_barrier
  ds_read_b64_tr_b16 a[208:209], v44 offset:32768
  ds_read_b64_tr_b16 a[210:211], v44 offset:33792
  ds_read_b64_tr_b16 a[212:213], v44 offset:40960
  ds_read_b64_tr_b16 a[214:215], v44 offset:41984
  ds_read_b64_tr_b16 a[216:217], v45 offset:32768
  ds_read_b64_tr_b16 a[218:219], v45 offset:33792
  ds_read_b64_tr_b16 a[220:221], v45 offset:40960
  ds_read_b64_tr_b16 a[222:223], v45 offset:41984
  ds_read_b64_tr_b16 v[80:81], v46 offset:32768
  ds_read_b64_tr_b16 v[82:83], v46 offset:33792
  ds_read_b64_tr_b16 v[84:85], v46 offset:40960
  ds_read_b64_tr_b16 v[86:87], v46 offset:41984
  ds_read_b64_tr_b16 v[88:89], v47 offset:32768
  ds_read_b64_tr_b16 v[90:91], v47 offset:33792
  ds_read_b64_tr_b16 v[92:93], v47 offset:40960
  ds_read_b64_tr_b16 v[94:95], v47 offset:41984
  s_waitcnt lgkmcnt(0)
  s_barrier
  s_add_u32 m0, s88, 0x18000
  s_add_u32 s10, s90, 0x0
  buffer_load_dwordx4 v38, s[40:43], s10 offen lds
  s_add_u32 m0, s88, 0x18400
  s_add_u32 s10, s90, 0x2000
  buffer_load_dwordx4 v38, s[40:43], s10 offen lds
  s_add_u32 m0, s88, 0x18800
  s_add_u32 s10, s90, 0x8000
  buffer_load_dwordx4 v38, s[40:43], s10 offen lds
  s_add_u32 m0, s88, 0x18c00
  s_add_u32 s10, s90, 0xa000
  buffer_load_dwordx4 v38, s[40:43], s10 offen lds
  s_add_u32 m0, s88, 0x1c000
  s_add_u32 s10, s90, 0x0
  buffer_load_dwordx4 v39, s[40:43], s10 offen lds
  s_add_u32 m0, s88, 0x1c400
  s_add_u32 s10, s90, 0x2000
  buffer_load_dwordx4 v39, s[40:43], s10 offen lds
  s_add_u32 m0, s88, 0x1c800
  s_add_u32 s10, s90, 0x8000
  buffer_load_dwordx4 v39, s[40:43], s10 offen lds
  s_add_u32 m0, s88, 0x1cc00
  s_add_u32 s10, s90, 0xa000
  buffer_load_dwordx4 v39, s[40:43], s10 offen lds
  buffer_load_dword v43, v36, s[68:71], 0 offen sc1
  ds_write_b128 v33, v[80:83] offset:32768
  ds_write_b128 v33, v[84:87] offset:33792
  ds_write_b128 v33, v[88:91] offset:34816
  ds_write_b128 v33, v[92:95] offset:35840
  ds_write_b128 v33, v[112:115] offset:49152
  ds_write_b128 v33, v[116:119] offset:50176
  ds_write_b128 v33, v[120:123] offset:51200
  ds_write_b128 v33, v[124:127] offset:52224
  s_waitcnt lgkmcnt(0)
  s_mov_b32 s12, 0
  s_lshl_b32 s13, s5, 8
  s_add_u32 s13, s13, 12288
  s_lshl_b32 s76, s5, 8
  s_add_u32 s15, s76, 0x80000
  s_and_b32 s76, s76, 0x300
  s_lshr_b32 s10, s5, 3
  s_lshl_b32 s10, s10, 11
  s_add_u32 s76, s76, s10
  s_and_b32 s10, s5, 4
  s_lshl_b32 s10, s10, 5
  s_add_u32 s76, s76, s10
  s_add_u32 s19, s76, 0x12000
  s_add_u32 s22, s76, 0x14000
  s_lshr_b32 s20, s78, 0
  s_add_u32 s20, s20, 0x10000
  s_lshl_b32 s76, s5, 13
  s_add_u32 s17, s76, 0x80000
  s_add_u32 s18, s17, 0x1000
  s_lshl_b32 s76, s5, 14
  s_add_u32 s23, s76, s78
  s_add_u32 s23, s23, 0x400000
  s_add_u32 s24, s23, 8192
  s_add_u32 s7, s76, s9
  s_add_u32 s7, s7, 0x400000
  s_lshl_b32 s76, s5, 8
  s_add_u32 s25, s76, 0x300000
  s_lshl_b32 s10, s5, 7
  s_add_u32 s10, s10, 0x5000
  s_cmp_eq_u32 s4, 3
  s_cselect_b64 s[40:41], 1, 0
  s_cmp_eq_u32 s4, 2
  s_cselect_b64 s[40:41], -1, s[40:41]
  s_cselect_b32 s25, s25, s10
  s_cselect_b32 s26, 8192, 0
  s_cselect_b32 s42, s76, 31744
  v_mov_b32 v15, 0
  v_lshrrev_b32 v14, 2, v1
  ds_write_b32 v14, v15 offset:31744
  s_mul_i32 s9, s4, 576
  s_lshl_b32 s43, s4, 10
  s_mov_b32 s3, 0
  s_lshl_b32 s76, s5, 7
  s_lshl_b32 s10, s4, 2
  s_add_u32 s76, s76, s10
  s_add_u32 s27, s76, 0x2040
  s_mov_b32 s28, 0x3e0293ee
  s_mov_b32 s29, 0x21800000
  s_mov_b32 s79, 0x3c000000
  s_mov_b32 s30, 0xffffffff
  s_cmp_ge_u32 s4, 2
  s_cselect_b32 s30, 0xfffffff, s30
  s_mov_b32 s31, 0
  s_lshl_b32 s7, s5, 14
  s_and_b32 s10, s4, 1
  s_lshl_b32 s10, s10, 13
  s_add_u32 s7, s7, s10
  s_add_u32 s7, s7, 0x400000
  s_cmp_ge_u32 s4, 2
  s_cselect_b32 s7, s7, 0x40000000
  s_mov_b32 s30, -1
  s_cselect_b32 s31, 0xfffffff, -1
  s_cselect_b32 s91, 0, 768
  s_add_u32 s91, s91, 31232
  s_mov_b32 s76, 0x05040100
  s_mov_b32 s14, 0x07060302
  v_perm_b32 v24, v22, v20, s76
  v_perm_b32 v25, v22, v20, s14
  v_perm_b32 v26, v23, v21, s76
  v_perm_b32 v27, v23, v21, s14
  ds_write_b128 v3, v[24:27] offset:1024
  v_perm_b32 v20, v30, v28, s76
  v_perm_b32 v21, v30, v28, s14
  v_perm_b32 v22, v31, v29, s76
  v_perm_b32 v23, v31, v29, s14
  ds_write_b128 v3, v[20:23] offset:0
  s_mov_b32 s76, 4
  s_waitcnt vmcnt(17)
  s_mov_b32 s14, 0
  s_branch L_kvp_5c
L_kvp_5:
  buffer_load_dword v40, v41, s[72:75], s13 offen sc1
  s_add_u32 s14, s14, 1
  s_cmp_gt_u32 s14, 200000
  s_cbranch_scc1 L_end
  s_waitcnt vmcnt(0)
L_kvp_5c:
  v_lshlrev_b32 v40, 3, v40
  v_lshrrev_b32 v42, 5, v41
  v_add_u32 v40, v40, v42
  v_cmp_ge_u32 vcc, s76, v40
  s_nop 0
  s_and_b32 s10, vcc_lo, 3
  s_cbranch_scc1 L_kvp_5
  s_mov_b32 m0, 31472
  s_nop 0
  buffer_load_dword v41, s[72:75], s13 offen sc1 lds
  s_add_u32 m0, s78, 8192
  s_nop 0
  buffer_load_dwordx4 v1, s[72:75], s23 offen sc1 lds
  buffer_load_dwordx4 v1, s[72:75], s23 offen offset:1024 sc1 lds
  s_add_u32 m0, s78, 16384
  s_nop 0
  buffer_load_dwordx4 v1, s[72:75], s24 offen sc1 lds
  buffer_load_dwordx4 v1, s[72:75], s24 offen offset:1024 sc1 lds
  s_mov_b32 m0, s91
  s_and_b32 s44, s4, 1
  s_lshl_b32 s44, s44, 12
  s_add_u32 s23, s23, 0x80000
  s_sub_u32 s23, s23, s78
  s_add_u32 s23, s23, s44
  s_add_u32 s24, s24, 0x80000
  s_add_u32 s77, s7, 0x80000
  s_mov_b32 s47, s77
  s_waitcnt vmcnt(14)
  s_barrier
  v_add_u32 v60, 0x10000, v56
  v_add_u32 v61, 0x10000, v57
  v_add_u32 v62, 0x10000, v58
  v_add_u32 v63, 0x10000, v59
  ds_read_b64_tr_b16 v[240:241], v60 offset:0
  ds_read_b64_tr_b16 v[242:243], v61 offset:512
  ds_read_b64_tr_b16 v[244:245], v60 offset:1024
  ds_read_b64_tr_b16 v[246:247], v61 offset:1536
  ds_read_b64_tr_b16 v[248:249], v62 offset:0
  ds_read_b64_tr_b16 v[250:251], v63 offset:512
  ds_read_b64_tr_b16 v[252:253], v62 offset:1024
  ds_read_b64_tr_b16 v[254:255], v63 offset:1536
  v_add_u32 v60, 0x10000, v56
  v_add_u32 v61, 0x10000, v57
  v_add_u32 v62, 0x10000, v58
  v_add_u32 v63, 0x10000, v59
  ds_read_b64_tr_b16 v[112:113], v60 offset:16384
  ds_read_b64_tr_b16 v[114:115], v61 offset:16896
  ds_read_b64_tr_b16 v[116:117], v60 offset:17408
  ds_read_b64_tr_b16 v[118:119], v61 offset:17920
  ds_read_b64_tr_b16 v[120:121], v62 offset:16384
  ds_read_b64_tr_b16 v[122:123], v63 offset:16896
  ds_read_b64_tr_b16 v[124:125], v62 offset:17408
  ds_read_b64_tr_b16 v[126:127], v63 offset:17920
  s_waitcnt lgkmcnt(0)
  s_barrier
  s_add_u32 m0, s88, 0x20000
  s_add_u32 s10, s89, 0x80
  buffer_load_dwordx4 v32, s[52:55], s10 offen lds
  s_add_u32 m0, s88, 0x20400
  s_add_u32 s10, s89, 0x2080
  buffer_load_dwordx4 v32, s[52:55], s10 offen lds
  s_add_u32 m0, s88, 0x20800
  s_add_u32 s10, s89, 0x1080
  buffer_load_dwordx4 v32, s[52:55], s10 offen lds
  s_add_u32 m0, s88, 0x20c00
  s_add_u32 s10, s89, 0x3080
  buffer_load_dwordx4 v32, s[52:55], s10 offen lds
  s_add_u32 m0, s88, 0x24000
  s_add_u32 s10, s89, 0xc0
  buffer_load_dwordx4 v32, s[52:55], s10 offen lds
  s_add_u32 m0, s88, 0x24400
  s_add_u32 s10, s89, 0x20c0
  buffer_load_dwordx4 v32, s[52:55], s10 offen lds
  s_add_u32 m0, s88, 0x24800
  s_add_u32 s10, s89, 0x10c0
  buffer_load_dwordx4 v32, s[52:55], s10 offen lds
  s_add_u32 m0, s88, 0x24c00
  s_add_u32 s10, s89, 0x30c0
  buffer_load_dwordx4 v32, s[52:55], s10 offen lds
  s_mov_b32 m0, s91
  ds_write_b128 v34, v[112:115] offset:0
  ds_write_b128 v34, v[116:119] offset:1024
  ds_write_b128 v34, v[120:123] offset:2048
  ds_write_b128 v34, v[124:127] offset:3072
  ds_write_b128 v34, v[96:99] offset:16384
  ds_write_b128 v34, v[100:103] offset:17408
  ds_write_b128 v34, v[104:107] offset:18432
  ds_write_b128 v34, v[108:111] offset:19456
  s_waitcnt lgkmcnt(0)
  s_waitcnt vmcnt(14)
  s_barrier
  ds_read_b64_tr_b16 v[96:97], v48 offset:32768
  ds_read_b64_tr_b16 v[98:99], v48 offset:33792
  ds_read_b64_tr_b16 v[100:101], v48 offset:40960
  ds_read_b64_tr_b16 v[102:103], v48 offset:41984
  ds_read_b64_tr_b16 v[104:105], v49 offset:32768
  ds_read_b64_tr_b16 v[106:107], v49 offset:33792
  ds_read_b64_tr_b16 v[108:109], v49 offset:40960
  ds_read_b64_tr_b16 v[110:111], v49 offset:41984
  ds_read_b64_tr_b16 v[112:113], v50 offset:32768
  ds_read_b64_tr_b16 v[114:115], v50 offset:33792
  ds_read_b64_tr_b16 v[116:117], v50 offset:40960
  ds_read_b64_tr_b16 v[118:119], v50 offset:41984
  ds_read_b64_tr_b16 v[120:121], v51 offset:32768
  ds_read_b64_tr_b16 v[122:123], v51 offset:33792
  ds_read_b64_tr_b16 v[124:125], v51 offset:40960
  ds_read_b64_tr_b16 v[126:127], v51 offset:41984
  s_waitcnt lgkmcnt(0)
  s_barrier
  ds_write_b128 v34, v[96:99] offset:32768
  ds_write_b128 v34, v[100:103] offset:33792
  ds_write_b128 v34, v[104:107] offset:34816
  ds_write_b128 v34, v[108:111] offset:35840
  ds_write_b128 v34, v[112:115] offset:49152
  ds_write_b128 v34, v[116:119] offset:50176
  ds_write_b128 v34, v[120:123] offset:51200
  ds_write_b128 v34, v[124:127] offset:52224
  s_waitcnt lgkmcnt(0)
  ds_read_b128 v[84:87], v2 offset:0
  ds_read_b128 v[88:91], v2 offset:1024
  ds_read_b128 v[92:95], v2 offset:2048
  ds_read_b128 v[96:99], v2 offset:3072
  ds_read_b128 v[68:71], v0 offset:16384
  ds_read_b128 v[72:75], v0 offset:17408
  ds_read_b128 v[76:79], v0 offset:18432
  ds_read_b128 v[80:83], v0 offset:19456
  s_and_b32 s36, s32, 0x1010101
  s_and_b32 s37, s32, 0x1010101
  v_xor_b32 v125, 2048, v3
  v_xor_b32 v126, 4096, v3
  v_xor_b32 v127, 6144, v3
  s_bfe_u32 s21, s12, 0x10001
  s_add_u32 s38, s12, 1
  v_lshrrev_b32 v14, 2, v1
  v_add_u32 v15, s42, v14
  v_add_u32 v14, s25, v14
  v_cndmask_b32_e64 v14, 2.0, v14, s[40:41]
  v_lshl_add_u32 v40, v1, 3, s77
  v_and_b32 v41, 16, v1
  v_lshl_add_u32 v41, v41, 3, s13
  v_cndmask_b32_e64 v4, v41, v40, s[30:31]
  s_waitcnt vmcnt(0)
  s_barrier
  v_add_u32 v60, 0x20000, v56
  v_add_u32 v61, 0x20000, v57
  v_add_u32 v62, 0x20000, v58
  v_add_u32 v63, 0x20000, v59
  ds_read_b64_tr_b16 v[100:101], v60 offset:0
  ds_read_b64_tr_b16 v[102:103], v61 offset:512
  ds_read_b64_tr_b16 v[104:105], v60 offset:1024
  ds_read_b64_tr_b16 v[106:107], v61 offset:1536
  ds_read_b64_tr_b16 v[44:45], v62 offset:0
  ds_read_b64_tr_b16 v[46:47], v63 offset:512
  ds_read_b64_tr_b16 v[48:49], v62 offset:1024
  ds_read_b64_tr_b16 v[50:51], v63 offset:1536
  v_add_u32 v60, 0x20000, v56
  v_add_u32 v61, 0x20000, v57
  v_add_u32 v62, 0x20000, v58
  v_add_u32 v63, 0x20000, v59
  ds_read_b64_tr_b16 v[108:109], v60 offset:16384
  ds_read_b64_tr_b16 v[110:111], v61 offset:16896
  ds_read_b64_tr_b16 v[112:113], v60 offset:17408
  ds_read_b64_tr_b16 v[114:115], v61 offset:17920
  ds_read_b64_tr_b16 v[116:117], v62 offset:16384
  ds_read_b64_tr_b16 v[118:119], v63 offset:16896
  ds_read_b64_tr_b16 v[120:121], v62 offset:17408
  ds_read_b64_tr_b16 v[122:123], v63 offset:17920
  s_waitcnt lgkmcnt(0)
  s_barrier
  ds_write_b128 v35, v[100:103] offset:0
  ds_write_b128 v35, v[104:107] offset:1024
  ds_write_b128 v35, v[44:47] offset:2048
  ds_write_b128 v35, v[48:51] offset:3072
  ds_write_b128 v35, v[108:111] offset:16384
  ds_write_b128 v35, v[112:115] offset:17408
  ds_write_b128 v35, v[116:119] offset:18432
  ds_write_b128 v35, v[120:123] offset:19456
  ds_read_b128 v[116:119], v2 offset:16384
  ds_read_b128 v[120:123], v2 offset:17408
  ds_read_b128 v[108:111], v2 offset:18432
  ds_read_b128 v[112:115], v2 offset:19456
  v_mov_b64 v[52:53], 0
  v_mov_b64 v[54:55], 0
  v_mov_b64 v[56:57], 0
  v_mov_b64 v[58:59], 0
  v_mov_b64 v[60:61], 0
  v_mov_b64 v[62:63], 0
  v_mov_b64 v[64:65], 0
  v_mov_b64 v[66:67], 0
  v_mov_b64 v[100:101], 0
  v_mov_b64 v[102:103], 0
  v_mov_b64 v[104:105], 0
  v_mov_b64 v[106:107], 0
  s_waitcnt vmcnt(0)
  v_cmp_eq_u32 vcc, 0, v43
  s_nop 0
  s_cmp_lg_u32 vcc_lo, 0
  s_cbranch_scc0 L_crdyx
  s_mov_b32 s14, 0
L_crdy:
  buffer_load_dword v43, v36, s[68:71], 0 offen sc1
  s_add_u32 s14, s14, 1
  s_cmp_gt_u32 s14, 200000
  s_cbranch_scc1 L_end
  s_waitcnt vmcnt(0)
  v_cmp_eq_u32 vcc, 0, v43
  s_nop 0
  s_cmp_lg_u32 vcc_lo, 0
  s_cbranch_scc1 L_crdy
L_crdyx:
  v_readfirstlane_b32 s10, v43
  s_nop 1
  v_cmp_ne_u32 vcc, s10, v43
  s_nop 0
  s_mov_b32 s6, vcc_lo
  v_smfmac_f32_16x16x64_bf16 v[52:55], v[20:23], v[84:91], v11
  v_smfmac_f32_16x16x64_bf16 v[56:59], v[20:23], v[92:99], v11
  v_smfmac_f32_16x16x64_bf16 v[60:63], v[20:23], a[128:135], v11
  v_smfmac_f32_16x16x64_bf16 v[64:67], v[20:23], a[136:143], v11
  v_smfmac_f32_16x16x64_bf16 v[100:103], v[20:23], a[0:7], v11
  s_cmp_lg_u32 s6, 0
  s_cbranch_scc1 L_c2S
  s_cmp_eq_u32 s6, 0
  s_branch L_c2F
  s_nop 0
  s_nop 0
  s_nop 0
  s_nop 0
  s_nop 0
  s_nop 0
  s_nop 0
  s_nop 0
  s_nop 0
  s_nop 0
  s_nop 0
  s_nop 0
  s_nop 0
  s_nop 0
  s_nop 0
  s_nop 0
  s_nop 0
  s_nop 0
  s_nop 0
  s_nop 0
  s_nop 0
  s_nop 0
  s_nop 0
  s_nop 0
  s_nop 0
  s_nop 0
  s_nop 0
  s_nop 0
  s_nop 0
  s_nop 0
  s_nop 0
  s_nop 0
  s_nop 0
  s_nop 0
  s_nop 0
  s_nop 0
  s_nop 0
  s_nop 0
  s_nop 0
  s_nop 0
  s_nop 0
  s_nop 0
  s_nop 0
  s_nop 0
  s_nop 0
  s_nop 0
  s_nop 0
  s_nop 0
  s_nop 0
  s_nop 0
  s_nop 0
  s_nop 0
  s_nop 0
  s_nop 0
  s_nop 0
  s_nop 0
  s_nop 0
  s_nop 0
  s_nop 0
  s_nop 0
  s_nop 0
  s_nop 0
  s_nop 0
  s_nop 0
  s_nop 0
  s_nop 0
  s_nop 0
  s_nop 0
  s_nop 0
  s_nop 0
  s_nop 0
  s_nop 0
  s_nop 0
  s_nop 0
  s_nop 0
  s_nop 0
  s_nop 0
  s_nop 0
  s_nop 0
  s_nop 0
  s_nop 0
  s_nop 0
  s_nop 0
  s_nop 0
  s_nop 0
  s_nop 0
  s_nop 0
  s_nop 0
  s_nop 0
  s_nop 0
  s_nop 0
  s_nop 0
  s_nop 0
  s_nop 0
  s_nop 0
  s_nop 0
  s_nop 0
  s_nop 0
  s_nop 0
  s_nop 0
  s_nop 0
  s_nop 0
  s_nop 0
  s_nop 0
  s_nop 0
  s_nop 0
  s_nop 0
  s_nop 0
  s_nop 0
  s_nop 0
  s_nop 0
  s_nop 0
  s_nop 0
  s_nop 0
  s_nop 0
  s_nop 0
  s_nop 0
  s_nop 0
  s_nop 0
  s_nop 0
  s_nop 0
  s_nop 0
  s_nop 0
  s_nop 0
  s_nop 0
  s_nop 0
  s_nop 0
  s_nop 0
  s_nop 0
  s_nop 0
  s_nop 0
  s_nop 0
  s_nop 0
  s_nop 0
  s_nop 0
  s_nop 0
  s_nop 0
  s_nop 0
  s_nop 0
  s_nop 0
  s_nop 0
  s_nop 0
  s_nop 0
  s_nop 0
  s_nop 0
  s_nop 0
  s_nop 0
  s_nop 0
  s_nop 0
  s_nop 0
  s_nop 0
  s_nop 0
  s_nop 0
  s_nop 0
  s_nop 0
  s_nop 0
  s_nop 0
  s_nop 0
  s_nop 0
  s_nop 0
L_topF:
  s_add_u32 m0, s78, 16384
  s_xor_b32 s17, s17, 0x40000
  buffer_load_dwordx4 v1, s[72:75], s24 offen offset:0 nt lds
  buffer_load_dwordx4 v1, s[72:75], s24 offen offset:1024 nt lds
  s_mov_b32 m0, s91
  s_xor_b32 s18, s18, 0x40000
  s_add_u32 s19, s19, 0x2000
  s_and_b32 s19, s19, 0xffff7fff
  s_add_u32 s22, s22, 0x2000
  s_and_b32 s22, s22, 0xffff7fff
  s_add_u32 s77, s12, 2
  s_min_u32 s77, s77, 63
  s_lshl_b32 s76, s77, 2
  s_add_u32 s12, s12, 1
  s_xor_b32 s15, s15, 0x40000
  s_add_u32 s25, s25, s26
  s_lshl_b32 s77, s77, 19
  s_add_u32 s77, s77, s7
  s_mov_b32 s47, s77
  s_add_u32 s23, s23, 524288
  s_add_u32 s24, s24, 524288
  v_mov_b64 v[60:61], 0
  v_mov_b64 v[62:63], 0
  v_mov_b64 v[64:65], 0
  v_mov_b64 v[66:67], 0
  buffer_load_dwordx4 v[20:23], v1, s[72:75], s20 offen offset:0 sc1
  v_mov_b64 v[100:101], 0
  v_mov_b64 v[102:103], 0
  v_mov_b64 v[104:105], 0
  v_mov_b64 v[106:107], 0
  s_bfe_u32 s21, s12, 0x10001
  s_add_u32 s38, s12, 1
  v_lshrrev_b32 v14, 2, v1
  v_add_u32 v15, s42, v14
  v_add_u32 v14, s25, v14
  v_cndmask_b32_e64 v14, 2.0, v14, s[40:41]
  v_lshl_add_u32 v40, v1, 3, s77
  v_and_b32 v41, 16, v1
  v_lshl_add_u32 v41, v41, 3, s13
  v_cndmask_b32_e64 v4, v41, v40, s[30:31]
  s_waitcnt lgkmcnt(0)
  v_mad_u32_u24 v52, v52, 8, v53
  v_cmp_ge_u32 vcc, s76, v52
  buffer_load_dwordx4 v[24:27], v1, s[72:75], s20 offen offset:1024 sc1
  s_and_b32 s8, vcc_lo, 3
  s_cbranch_scc1 L_kvwF
L_kvrF:
  v_mov_b64 v[52:53], 0
  v_mov_b64 v[54:55], 0
  v_mov_b64_e64 v[56:57], 0
  v_mov_b64_e64 v[58:59], 0
  s_cmp_lt_u32 s12, 63
  s_waitcnt vmcnt(1)
  v_max3_u32 v28, v20, v21, v22
  v_max_u32 v28, v28, v23
  v_cmp_eq_u32 vcc, -1, v28
  ds_write_b128 v3, v[20:23] offset:0
  s_cbranch_vccnz L_pm0F
  v_smfmac_f32_16x16x64_bf16 v[52:55], v[20:23], v[84:91], v11
  v_smfmac_f32_16x16x64_bf16 v[56:59], v[20:23], v[92:99], v11
  v_smfmac_f32_16x16x64_bf16 v[60:63], v[20:23], a[128:135], v11
  s_waitcnt vmcnt(0)
L_c1F:
  ds_write_b128 v3, v[24:27] offset:1024
  v_max3_u32 v28, v24, v25, v26
  v_max_u32 v28, v28, v27
  v_cmp_eq_u32 vcc, -1, v28
  v_smfmac_f32_16x16x64_bf16 v[64:67], v[20:23], a[136:143], v11
  v_smfmac_f32_16x16x64_bf16 v[100:103], v[20:23], a[0:7], v11
  s_cbranch_vccnz L_pm1F
L_c2F:
  s_cbranch_scc0 L_tail
  v_smfmac_f32_16x16x64_bf16 v[104:107], v[20:23], a[8:15], v11
  s_waitcnt lgkmcnt(0)
  s_barrier
L_stepF:
  ds_read_b128 v[28:31], v125 offset:0
  v_smfmac_f32_16x16x64_bf16 v[52:55], v[24:27], v[68:75], v11
  buffer_load_dword v4, s[72:75], 0 offen sc1 lds
  v_smfmac_f32_16x16x64_bf16 v[56:59], v[24:27], v[76:83], v11
  ds_read_b128 v[32:35], v125 offset:1024
  v_smfmac_f32_16x16x64_bf16 v[60:63], v[24:27], a[144:151], v11
  ds_read_b128 v[36:39], v126 offset:0
  v_smfmac_f32_16x16x64_bf16 v[64:67], v[24:27], a[152:159], v11
  ds_read_b128 v[40:43], v126 offset:1024
  v_smfmac_f32_16x16x64_bf16 v[100:103], v[24:27], a[16:23], v11
  ds_read_b128 v[44:47], v127 offset:0
  v_smfmac_f32_16x16x64_bf16 v[104:107], v[24:27], a[24:31], v11
  ds_read_b128 v[48:51], v127 offset:1024
  s_waitcnt lgkmcnt(5)
  v_smfmac_f32_16x16x64_bf16 v[52:55], v[28:31], v[116:123], v11
  ds_read_b32 v124, v15
  v_smfmac_f32_16x16x64_bf16 v[56:59], v[28:31], v[108:115], v11
  ds_read_b128 v[68:71], v0 offset:51200
  s_waitcnt lgkmcnt(6)
  v_smfmac_f32_16x16x64_bf16 v[52:55], v[32:35], a[224:231], v11
  ds_read_b128 v[72:75], v0 offset:52224
  v_smfmac_f32_16x16x64_bf16 v[56:59], v[32:35], a[232:239], v11
  ds_read_b128 v[76:79], v0 offset:2048
  s_waitcnt lgkmcnt(7)
  v_smfmac_f32_16x16x64_bf16 v[52:55], v[36:39], a[240:247], v11
  ds_read_b128 v[80:83], v0 offset:3072
  v_smfmac_f32_16x16x64_bf16 v[56:59], v[36:39], a[248:255], v11
  s_waitcnt lgkmcnt(4)
  buffer_store_dword v124, v14, s[72:75], 0 offen sc1
  v_smfmac_f32_16x16x64_bf16 v[52:55], v[40:43], v[128:135], v11
  ds_read_b128 v[116:119], v0 offset:49152
  v_smfmac_f32_16x16x64_bf16 v[56:59], v[40:43], v[136:143], v11
  ds_read_b128 v[120:123], v0 offset:50176
  v_smfmac_f32_16x16x64_bf16 v[52:55], v[44:47], v[144:151], v11
  ds_read_b128 v[108:111], v0 offset:0
  v_smfmac_f32_16x16x64_bf16 v[56:59], v[44:47], v[152:159], v11
  ds_read_b128 v[112:115], v0 offset:1024
  v_smfmac_f32_16x16x64_bf16 v[52:55], v[48:51], v[160:167], v11
  v_smfmac_f32_16x16x64_bf16 v[56:59], v[48:51], v[168:175], v11
  v_smfmac_f32_16x16x64_bf16 v[60:63], v[28:31], a[160:167], v11
  ds_read_b128 v[84:87], v1 offset:8192
  v_add_f32 v52, v52, v54
  v_smfmac_f32_16x16x64_bf16 v[64:67], v[28:31], a[168:175], v11
  ds_read_b128 v[88:91], v1 offset:9216
  v_add_f32 v53, v53, v55
  v_smfmac_f32_16x16x64_bf16 v[60:63], v[32:35], a[176:183], v11
  ds_read_b128 v[92:95], v1 offset:10240
  v_add_f32 v56, v56, v58
  v_smfmac_f32_16x16x64_bf16 v[64:67], v[32:35], a[184:191], v11
  ds_read_b128 v[96:99], v1 offset:11264
  v_add_f32 v57, v57, v59
  v_smfmac_f32_16x16x64_bf16 v[60:63], v[36:39], a[192:199], v11
  v_cvt_pk_bf16_f32 v52, v52, v56
  v_smfmac_f32_16x16x64_bf16 v[64:67], v[36:39], a[200:207], v11
  v_cvt_pk_bf16_f32 v53, v53, v57
  v_smfmac_f32_16x16x64_bf16 v[60:63], v[40:43], a[208:215], v11
  ds_write_b32 v5, v52 offset:26880
  v_smfmac_f32_16x16x64_bf16 v[64:67], v[40:43], a[216:223], v11
  s_waitcnt lgkmcnt(7)
  ds_write_b32 v5, v53 offset:27168
  v_mov_b32 v15, -1
  v_smfmac_f32_16x16x64_bf16 v[60:63], v[44:47], v[116:123], v11
  s_waitcnt vmcnt(2)
  v_mov_b64 v[20:21], 0
  v_smfmac_f32_16x16x64_bf16 v[64:67], v[44:47], v[68:75], v11
  s_waitcnt lgkmcnt(6)
  ds_read_b128 v[52:55], v1 offset:12288
  v_mov_b64 v[22:23], 0
  v_smfmac_f32_16x16x64_bf16 v[60:63], v[48:51], v[108:115], v11
  ds_read_b128 v[56:59], v1 offset:13312
  v_mov_b64 v[24:25], 0
  v_smfmac_f32_16x16x64_bf16 v[64:67], v[48:51], v[76:83], v11
  v_mov_b64 v[26:27], 0
  v_smfmac_f32_16x16x64_bf16 v[100:103], v[28:31], a[32:39], v11
  s_waitcnt lgkmcnt(2)
  s_barrier
  ds_read_b128 v[68:71], v6 offset:26880
  v_add_f32 v60, v60, v62
  v_smfmac_f32_16x16x64_bf16 v[104:107], v[28:31], a[40:47], v11
  ds_read_b128 v[72:75], v6 offset:26944
  v_add_f32 v61, v61, v63
  v_smfmac_f32_16x16x64_bf16 v[100:103], v[32:35], a[48:55], v11
  ds_read_b128 v[76:79], v6 offset:27008
  v_add_f32 v64, v64, v66
  v_smfmac_f32_16x16x64_bf16 v[104:107], v[32:35], a[56:63], v11
  ds_read_b128 v[80:83], v6 offset:27072
  v_add_f32 v65, v65, v67
  v_smfmac_f32_16x16x64_bf16 v[100:103], v[36:39], a[64:71], v11
  ds_read_b128 v[108:111], v1 offset:14336
  v_cvt_pk_bf16_f32 v60, v60, v64
  v_smfmac_f32_16x16x64_bf16 v[104:107], v[36:39], a[72:79], v11
  s_waitcnt lgkmcnt(4)
  ds_read_b128 v[112:115], v1 offset:15360
  v_cvt_pk_bf16_f32 v61, v61, v65
  v_mfma_f32_16x16x32_bf16 v[116:119], v[84:87], v[68:71], 0
  s_waitcnt lgkmcnt(4)
  ds_write_b32 v5, v60 offset:24576
  v_cndmask_b32_e64 v124, 2.0, v7, s[36:37]
  v_mfma_f32_16x16x32_bf16 v[116:119], v[88:91], v[72:75], v[116:119]
  s_waitcnt lgkmcnt(4)
  ds_write_b32 v5, v61 offset:24864
  v_mov_b64_e64 v[28:29], 0
  v_mfma_f32_16x16x32_bf16 v[116:119], v[92:95], v[76:79], v[116:119]
  s_waitcnt lgkmcnt(4)
  v_mov_b64_e64 v[30:31], 0
  v_mfma_f32_16x16x32_bf16 v[116:119], v[96:99], v[80:83], v[116:119]
  v_mov_b64_e64 v[32:33], 0
  v_mfma_f32_16x16x32_bf16 v[120:123], v[52:55], v[68:71], 0
  v_mov_b64_e64 v[34:35], 0
  v_mfma_f32_16x16x32_bf16 v[120:123], v[56:59], v[72:75], v[120:123]
  s_waitcnt lgkmcnt(3)
  v_exp_f32 v116, v116
  v_mfma_f32_16x16x32_bf16 v[120:123], v[108:111], v[76:79], v[120:123]
  s_waitcnt lgkmcnt(2)
  s_waitcnt lgkmcnt(0)
  s_barrier
  v_exp_f32 v117, v117
  v_mfma_f32_16x16x32_bf16 v[120:123], v[112:115], v[80:83], v[120:123]
  v_exp_f32 v118, v118
  v_smfmac_f32_16x16x64_bf16 v[100:103], v[40:43], a[80:87], v11
  ds_read_b128 v[84:87], v6 offset:24576
  v_exp_f32 v119, v119
  v_smfmac_f32_16x16x64_bf16 v[104:107], v[40:43], a[88:95], v11
  ds_read_b128 v[88:91], v6 offset:24640
  v_cvt_pk_bf16_f32 v116, v116, v117
  v_smfmac_f32_16x16x64_bf16 v[100:103], v[44:47], a[96:103], v11
  ds_read_b128 v[92:95], v6 offset:24704
  v_cvt_pk_bf16_f32 v117, v118, v119
  v_smfmac_f32_16x16x64_bf16 v[104:107], v[44:47], a[104:111], v11
  ds_read_b128 v[96:99], v6 offset:24768
  v_exp_f32 v120, v120
  v_smfmac_f32_16x16x64_bf16 v[100:103], v[48:51], a[112:119], v11
  ds_read_b128 v[56:59], v3 offset:16384
  ds_read_b128 v[108:111], v3 offset:17408
  s_waitcnt lgkmcnt(5)
  v_mfma_f32_16x16x32_bf16 v[36:39], v[84:87], v[68:71], 0
  s_waitcnt lgkmcnt(4)
  v_exp_f32 v121, v121
  v_mfma_f32_16x16x32_bf16 v[36:39], v[88:91], v[72:75], v[36:39]
  s_waitcnt lgkmcnt(3)
  v_exp_f32 v122, v122
  v_mfma_f32_16x16x32_bf16 v[36:39], v[92:95], v[76:79], v[36:39]
  s_waitcnt lgkmcnt(2)
  v_exp_f32 v123, v123
  v_mfma_f32_16x16x32_bf16 v[36:39], v[96:99], v[80:83], v[36:39]
  v_cvt_pk_bf16_f32 v118, v120, v121
  v_cvt_pk_bf16_f32 v119, v122, v123
  v_smfmac_f32_16x16x64_bf16 v[104:107], v[48:51], a[120:127], v11
  ds_write_b32 v3, v15 offset:16392
  v_mfma_f32_16x16x32_bf16 v[52:55], v[16:19], v[116:119], 0
  s_waitcnt lgkmcnt(1)
  v_mul_f32 v36, s28, v36
  v_mul_f32 v37, s28, v37
  v_mfma_f32_16x16x32_bf16 v[60:63], v[56:59], v[116:119], 0
  v_exp_f32 v36, v36
  v_mfma_f32_16x16x32_bf16 v[64:67], v[108:111], v[116:119], 0
  s_waitcnt lgkmcnt(0)
  v_exp_f32 v37, v37
  v_cvt_pk_bf16_f32 v100, v100, v101
  v_cvt_pk_bf16_f32 v14, v36, v37
  v_cvt_pk_bf16_f32 v15, v36, v37
  v_cvt_pk_bf16_f32 v101, v102, v103
  v_cvt_pk_bf16_f32 v102, v104, v105
  v_mfma_f32_16x16x16_bf16 v[52:55], v[12:13], v[14:15], v[52:55]
  ds_read_b128 v[68:71], v0 offset:32768
  v_cvt_pk_bf16_f32 v103, v106, v107
  v_mfma_f32_16x16x16_bf16 v[60:63], v[100:101], v[14:15], v[60:63]
  ds_read_b128 v[72:75], v0 offset:33792
  v_mfma_f32_16x16x16_bf16 v[64:67], v[102:103], v[14:15], v[64:67]
  v_rcp_f32 v55, v54
  v_subrev_u32 v53, s29, v54
  v_cmp_le_u32 vcc, s79, v53
  v_mov_b32 v14, s38
  v_mul_f32 v60, v55, v60
  v_mul_f32 v61, v55, v61
  v_mul_f32 v62, v55, v62
  v_mul_f32 v63, v55, v63
  v_cvt_pk_bf16_f32 v60, v60, v61
  v_cvt_pk_bf16_f32 v61, v62, v63
  ds_write_b64 v3, v[60:61] offset:16384
  v_mul_f32 v64, v55, v64
  v_mul_f32 v65, v55, v65
  v_mul_f32 v66, v55, v66
  v_mul_f32 v67, v55, v67
  v_cvt_pk_bf16_f32 v62, v64, v65
  v_cvt_pk_bf16_f32 v63, v66, v67
  ds_write_b64 v3, v[62:63] offset:16392
  buffer_store_dword v14, v124, s[72:75], s34 offen offset:2048
  v_smfmac_f32_16x16x64_bf16 v[20:23], v[60:63], v[176:183], v11
  s_barrier
  ds_read_b128 v[40:43], v125 offset:16384
  ds_read_b128 v[44:47], v126 offset:16384
  ds_read_b128 v[36:39], v127 offset:16384
  v_smfmac_f32_16x16x64_bf16 v[24:27], v[60:63], v[192:199], v11
  buffer_store_dword v14, v124, s[72:75], s34 offen offset:0
  s_cbranch_vccnz L_fbF
L_fbretF:
  v_smfmac_f32_16x16x64_bf16 v[28:31], v[60:63], v[208:215], v11
  ds_read_b128 v[76:79], v0 offset:34816
  ds_read_b128 v[80:83], v0 offset:35840
  v_smfmac_f32_16x16x64_bf16 v[32:35], v[60:63], v[224:231], v11
  ds_read_b128 v[84:87], v2 offset:32768
  ds_read_b128 v[88:91], v2 offset:33792
  s_waitcnt lgkmcnt(6)
  v_smfmac_f32_16x16x64_bf16 v[20:23], v[40:43], v[184:191], v11
  ds_read_b128 v[92:95], v2 offset:34816
  s_waitcnt lgkmcnt(6)
  v_smfmac_f32_16x16x64_bf16 v[20:23], v[44:47], v[240:247], v11
  ds_read_b128 v[96:99], v2 offset:35840
  s_waitcnt lgkmcnt(6)
  v_smfmac_f32_16x16x64_bf16 v[20:23], v[36:39], v[248:255], v11
  ds_read_b128 v[116:119], v2 offset:49152
  ds_read_b128 v[120:123], v2 offset:50176
  v_max3_u32 v48, v42, v46, v38
  v_smfmac_f32_16x16x64_bf16 v[24:27], v[40:43], v[200:207], v11
  buffer_load_dword v54, v10, s[72:75], s35 offen sc1
  v_cmp_eq_u32 vcc, -1, v48
  v_smfmac_f32_16x16x64_bf16 v[24:27], v[44:47], v[68:75], v11
  s_waitcnt lgkmcnt(6)
  ds_read_b128 v[108:111], v2 offset:51200
  ds_read_b128 v[112:115], v2 offset:52224
  v_cvt_pk_bf16_f32 v20, v20, v22
  v_smfmac_f32_16x16x64_bf16 v[24:27], v[36:39], v[76:83], v11
  buffer_store_dword v14, v124, s[72:75], s34 offen offset:128
  s_cbranch_vccnz L_oxF
L_oxretF:
  v_cvt_pk_bf16_f32 v21, v21, v23
  v_smfmac_f32_16x16x64_bf16 v[28:31], v[40:43], v[216:223], v11
  s_waitcnt lgkmcnt(6)
  buffer_load_dword v55, v10, s[72:75], s35 offen sc1
  v_and_or_b32 v20, v20, -2, s21
  v_smfmac_f32_16x16x64_bf16 v[28:31], v[44:47], v[84:91], v11
  s_waitcnt lgkmcnt(4)
  buffer_store_dwordx2 v[20:21], v8, s[72:75], s15 offen offset:0
  v_cvt_pk_bf16_f32 v24, v24, v26
  v_smfmac_f32_16x16x64_bf16 v[28:31], v[36:39], v[92:99], v11
  v_cvt_pk_bf16_f32 v25, v25, v27
  v_smfmac_f32_16x16x64_bf16 v[32:35], v[40:43], v[232:239], v11
  s_waitcnt lgkmcnt(2)
  s_cmp_lg_u32 s4, 1
  v_and_or_b32 v24, v24, -2, s21
  v_smfmac_f32_16x16x64_bf16 v[32:35], v[44:47], v[116:123], v11
  s_waitcnt lgkmcnt(0)
  buffer_store_dwordx2 v[24:25], v8, s[72:75], s15 offen offset:64
  v_cvt_pk_bf16_f32 v28, v28, v30
  v_smfmac_f32_16x16x64_bf16 v[32:35], v[36:39], v[108:115], v11
  v_cvt_pk_bf16_f32 v29, v29, v31
  v_and_or_b32 v28, v28, -2, s21
  buffer_store_dwordx2 v[28:29], v8, s[72:75], s15 offen offset:128
  s_nop 4
  v_cvt_pk_bf16_f32 v32, v32, v34
  v_cvt_pk_bf16_f32 v33, v33, v35
  v_and_or_b32 v32, v32, -2, s21
  buffer_store_dwordx2 v[32:33], v8, s[72:75], s15 offen offset:192
  s_barrier
  s_cbranch_scc1 L_othF
  buffer_load_dword v15, v10, s[72:75], s35 offen offset:128 sc1
  v_mov_b64 v[36:37], 0
  v_mov_b64 v[38:39], 0
  v_add_u32 v52, s43, v1
  v_lshrrev_b32 v53, 2, v1
  ds_write_b128 v52, v[100:103] offset:26880
  ds_read_b32 v52, v53 offset:31472
  s_add_u32 s20, s20, 0x2000
  s_and_b32 s20, s20, 0xffff7fff
  v_mov_b32_dpp v36, v16 quad_perm:[0,1,2,3] row_mask:0xf bank_mask:0x1
  v_mov_b32_dpp v37, v16 quad_perm:[0,1,2,3] row_mask:0xf bank_mask:0x2
  v_mov_b32_dpp v38, v16 quad_perm:[0,1,2,3] row_mask:0xf bank_mask:0x4
  v_mov_b32_dpp v39, v16 quad_perm:[0,1,2,3] row_mask:0xf bank_mask:0x8
  ds_read_b128 v[84:87], v2 offset:0
  ds_read_b128 v[88:91], v2 offset:1024
  ds_read_b128 v[92:95], v2 offset:2048
  ds_read_b128 v[96:99], v2 offset:3072
  ds_read_b128 v[68:71], v0 offset:16384
  ds_read_b128 v[72:75], v0 offset:17408
  ds_read_b128 v[76:79], v0 offset:18432
  ds_read_b128 v[80:83], v0 offset:19456
  ds_read_b128 v[116:119], v2 offset:16384
  ds_read_b128 v[120:123], v2 offset:17408
  ds_read_b128 v[108:111], v2 offset:18432
  ds_read_b128 v[112:115], v2 offset:19456
  s_nop 7
  s_nop 0
  s_nop 0
  s_nop 0
  s_nop 0
  v_cmp_ne_u32 vcc, s38, v54
  s_nop 0
  s_cmp_eq_u32 vcc_lo, 0
  s_cbranch_scc1 L_alrlF
  v_cmp_ne_u32 vcc, s38, v55
  buffer_load_dword v15, v10, s[72:75], s35 offen offset:128 sc1
  s_cmp_eq_u32 vcc_lo, 0
  s_cbranch_scc1 L_alrlF
  v_cmp_ne_u32 vcc, s38, v54
  buffer_load_dword v15, v10, s[72:75], s35 offen offset:128 sc1
  s_cmp_eq_u32 vcc_hi, 0
  s_cbranch_scc1 L_alrlF
  v_cmp_ne_u32 vcc, s38, v55
  buffer_load_dword v15, v10, s[72:75], s35 offen offset:128 sc1
  s_cmp_eq_u32 vcc_hi, 0
  s_cbranch_scc1 L_alrlF
  s_mov_b32 s14, 0
L_alllF:
  v_cmp_ne_u32 vcc, s38, v15
  buffer_load_dword v15, v10, s[72:75], s35 offen offset:128 sc1
  s_cmp_eq_u32 vcc_lo, 0
  s_cbranch_scc1 L_alqlF
  v_cmp_ne_u32 vcc, s38, v15
  buffer_load_dword v15, v10, s[72:75], s35 offen offset:128 sc1
  s_cmp_eq_u32 vcc_lo, 0
  s_cbranch_scc1 L_alqlF
  v_cmp_ne_u32 vcc, s38, v15
  buffer_load_dword v15, v10, s[72:75], s35 offen offset:128 sc1
  s_cmp_eq_u32 vcc_lo, 0
  s_cbranch_scc1 L_alqlF
  v_cmp_ne_u32 vcc, s38, v15
  buffer_load_dword v15, v10, s[72:75], s35 offen offset:128 sc1
  s_cmp_eq_u32 vcc_lo, 0
  s_cbranch_scc1 L_alqlF
  s_add_u32 s14, s14, 1
  s_cmp_lt_u32 s14, 40
  s_waitcnt vmcnt(40)
  s_cbranch_scc1 L_alllF
  s_nop 0
  s_nop 0
  s_nop 0
  s_nop 0
  s_nop 0
  s_nop 0
  s_nop 0
L_alqlF:
L_alrlF:
  buffer_load_dwordx4 v[20:23], v7, s[72:75], s17 offen offset:0 sc1
  buffer_load_dwordx4 v[24:27], v7, s[72:75], s17 offen offset:2048 sc1
  buffer_load_dwordx4 v[28:31], v7, s[72:75], s18 offen offset:0 sc1
  buffer_load_dwordx4 v[32:35], v7, s[72:75], s18 offen offset:2048 sc1
  s_barrier
  s_nop 0
  s_nop 0
L_rwF:
  s_waitcnt vmcnt(3)
  v_mfma_f32_16x16x32_bf16 v[48:51], v[36:39], v[20:23], 0
  v_bitop3_b32 v44, v20, v22, s21 bitop3:0x7e
  s_waitcnt vmcnt(2)
  v_mfma_f32_16x16x32_bf16 v[48:51], v[36:39], v[24:27], v[48:51]
  v_bitop3_b32 v45, v24, v26, s21 bitop3:0x7e
  s_waitcnt vmcnt(1)
  v_mfma_f32_16x16x32_bf16 v[48:51], v[36:39], v[28:31], v[48:51]
  v_bitop3_b32 v46, v28, v30, s21 bitop3:0x7e
  v_or3_b32 v44, v44, v45, v46
  v_and_b32 v44, 1, v44
  s_waitcnt vmcnt(0)
  v_mfma_f32_16x16x32_bf16 v[48:51], v[36:39], v[32:35], v[48:51]
  v_bitop3_b32 v47, v32, v34, s21 bitop3:0x7e
  v_and_or_b32 v44, v47, 1, v44
  v_cmp_ne_u32 vcc, 0, v44
L_redokF:
  s_nop 4
  v_add_f32_dpp v48, v48, v48 row_ror:8 row_mask:0xf bank_mask:0xf
  v_add_f32_dpp v49, v49, v49 row_ror:8 row_mask:0xf bank_mask:0xf
  s_cbranch_vccnz L_rednF
  v_cvt_pk_bf16_f32 v40, v48, v49
  buffer_store_dword v40, v9, s[72:75], s19 offen
L_b2F:
  s_barrier
  s_branch L_topF
  s_nop 0
  s_nop 0
  s_nop 0
  s_nop 0
L_othF:
  s_cmp_lg_u32 s4, 0
  s_cbranch_scc1 L_nrF
  buffer_load_dword v15, v10, s[72:75], s35 offen offset:128 sc1
  v_mov_b64 v[36:37], 0
  v_mov_b64 v[38:39], 0
  v_add_u32 v52, s43, v1
  v_lshrrev_b32 v53, 2, v1
  ds_write_b128 v52, v[100:103] offset:26880
  ds_read_b32 v52, v53 offset:31472
  s_add_u32 s20, s20, 0x2000
  s_and_b32 s20, s20, 0xffff7fff
  v_mov_b32_dpp v36, v16 quad_perm:[0,1,2,3] row_mask:0xf bank_mask:0x1
  v_mov_b32_dpp v37, v16 quad_perm:[0,1,2,3] row_mask:0xf bank_mask:0x2
  v_mov_b32_dpp v38, v16 quad_perm:[0,1,2,3] row_mask:0xf bank_mask:0x4
  v_mov_b32_dpp v39, v16 quad_perm:[0,1,2,3] row_mask:0xf bank_mask:0x8
  v_cmp_ne_u32 vcc, s38, v54
  s_nop 0
  s_cmp_eq_u32 vcc_lo, 0
  s_cbranch_scc1 L_alreF
  v_cmp_ne_u32 vcc, s38, v55
  buffer_load_dword v15, v10, s[72:75], s35 offen offset:128 sc1
  s_cmp_eq_u32 vcc_lo, 0
  s_cbranch_scc1 L_alreF
  v_cmp_ne_u32 vcc, s38, v54
  buffer_load_dword v15, v10, s[72:75], s35 offen offset:128 sc1
  s_cmp_eq_u32 vcc_hi, 0
  s_cbranch_scc1 L_alreF
  v_cmp_ne_u32 vcc, s38, v55
  buffer_load_dword v15, v10, s[72:75], s35 offen offset:128 sc1
  s_cmp_eq_u32 vcc_hi, 0
  s_cbranch_scc1 L_alreF
  s_mov_b32 s14, 0
L_alleF:
  v_cmp_ne_u32 vcc, s38, v15
  buffer_load_dword v15, v10, s[72:75], s35 offen offset:128 sc1
  s_cmp_eq_u32 vcc_lo, 0
  s_cbranch_scc1 L_alqeF
  v_cmp_ne_u32 vcc, s38, v15
  buffer_load_dword v15, v10, s[72:75], s35 offen offset:128 sc1
  s_cmp_eq_u32 vcc_lo, 0
  s_cbranch_scc1 L_alqeF
  v_cmp_ne_u32 vcc, s38, v15
  buffer_load_dword v15, v10, s[72:75], s35 offen offset:128 sc1
  s_cmp_eq_u32 vcc_lo, 0
  s_cbranch_scc1 L_alqeF
  v_cmp_ne_u32 vcc, s38, v15
  buffer_load_dword v15, v10, s[72:75], s35 offen offset:128 sc1
  s_cmp_eq_u32 vcc_lo, 0
  s_cbranch_scc1 L_alqeF
  s_add_u32 s14, s14, 1
  s_cmp_lt_u32 s14, 40
  s_waitcnt vmcnt(40)
  s_cbranch_scc1 L_alleF
  s_nop 0
L_alqeF:
L_alreF:
  buffer_load_dwordx4 v[20:23], v7, s[72:75], s17 offen offset:0 sc1
  buffer_load_dwordx4 v[24:27], v7, s[72:75], s17 offen offset:2048 sc1
  buffer_load_dwordx4 v[28:31], v7, s[72:75], s18 offen offset:0 sc1
  buffer_load_dwordx4 v[32:35], v7, s[72:75], s18 offen offset:2048 sc1
  ds_read_b128 v[84:87], v2 offset:0
  ds_read_b128 v[88:91], v2 offset:1024
  ds_read_b128 v[92:95], v2 offset:2048
  ds_read_b128 v[96:99], v2 offset:3072
  ds_read_b128 v[68:71], v0 offset:16384
  ds_read_b128 v[72:75], v0 offset:17408
  s_barrier
  ds_read_b128 v[76:79], v0 offset:18432
  ds_read_b128 v[80:83], v0 offset:19456
  ds_read_b128 v[116:119], v2 offset:16384
  ds_read_b128 v[120:123], v2 offset:17408
  ds_read_b128 v[108:111], v2 offset:18432
  ds_read_b128 v[112:115], v2 offset:19456
  s_branch L_rwF
L_tail:
  s_nop 7
  s_nop 7
  v_add_u32 v104, s43, v1
  s_waitcnt lgkmcnt(0)
  s_barrier
  ds_read_b128 v[104:107], v104 offset:26880
  v_bfe_u32 v100, v1, 8, 1
  v_lshl_add_u32 v100, v100, 5, v1
  v_add_u32 v100, s9, v100
  ds_read_b128 v[100:103], v100 offset:24576
  ds_read_b128 v[28:31], v125 offset:0
  ds_read_b128 v[32:35], v125 offset:1024
  ds_read_b128 v[36:39], v126 offset:0
  ds_read_b128 v[40:43], v126 offset:1024
  ds_read_b128 v[44:47], v127 offset:0
  ds_read_b128 v[48:51], v127 offset:1024
  s_lshl_b32 s76, s5, 13
  s_add_u32 s25, s76, 0x33c0000
  s_lshl_b32 s76, s4, 10
  s_add_u32 s26, s25, s76
  s_add_u32 s26, s26, 2048
  s_lshl_b32 s76, s4, 9
  s_add_u32 s25, s25, s76
  v_and_b32 v14, 512, v1
  v_lshl_or_b32 v14, v14, 21, v1
  v_min_u32 v15, 1, v1
  v_lshlrev_b32 v15, 30, v15
  v_mov_b32 v124, 64
  ds_read_b128 v[116:119], v0 offset:49152
  ds_read_b128 v[120:123], v0 offset:50176
  ds_read_b128 v[108:111], v0 offset:0
  ds_read_b128 v[112:115], v0 offset:1024
  ds_read_b128 v[68:71], v0 offset:51200
  ds_read_b128 v[72:75], v0 offset:52224
  ds_read_b128 v[76:79], v0 offset:2048
  ds_read_b128 v[80:83], v0 offset:3072
  v_mov_b64 v[52:53], 0
  v_mov_b64 v[54:55], 0
  v_mov_b64 v[56:57], 0
  v_mov_b64 v[58:59], 0
  v_mov_b64 v[60:61], 0
  v_mov_b64 v[62:63], 0
  v_mov_b64 v[64:65], 0
  v_mov_b64 v[66:67], 0
  s_waitcnt lgkmcnt(14)
  buffer_store_dwordx4 v[100:103], v14, s[72:75], s25 offen sc1
  buffer_store_dwordx4 v[104:107], v1, s[72:75], s26 offen sc1
  s_add_u32 s25, s25, 0x40000
  s_add_u32 s26, s26, 0x40000
  v_smfmac_f32_16x16x64_bf16 v[60:63], v[20:23], a[128:135], v11
  v_smfmac_f32_16x16x64_bf16 v[64:67], v[20:23], a[136:143], v11
  v_smfmac_f32_16x16x64_bf16 v[60:63], v[24:27], a[144:151], v11
  v_smfmac_f32_16x16x64_bf16 v[64:67], v[24:27], a[152:159], v11
  s_waitcnt lgkmcnt(13)
  v_smfmac_f32_16x16x64_bf16 v[60:63], v[28:31], a[160:167], v11
  v_smfmac_f32_16x16x64_bf16 v[64:67], v[28:31], a[168:175], v11
  s_waitcnt lgkmcnt(12)
  v_smfmac_f32_16x16x64_bf16 v[60:63], v[32:35], a[176:183], v11
  v_smfmac_f32_16x16x64_bf16 v[64:67], v[32:35], a[184:191], v11
  s_waitcnt lgkmcnt(11)
  v_smfmac_f32_16x16x64_bf16 v[60:63], v[36:39], a[192:199], v11
  v_smfmac_f32_16x16x64_bf16 v[64:67], v[36:39], a[200:207], v11
  s_waitcnt lgkmcnt(10)
  v_smfmac_f32_16x16x64_bf16 v[60:63], v[40:43], a[208:215], v11
  v_smfmac_f32_16x16x64_bf16 v[64:67], v[40:43], a[216:223], v11
  s_waitcnt lgkmcnt(2)
  v_smfmac_f32_16x16x64_bf16 v[60:63], v[44:47], v[116:123], v11
  v_smfmac_f32_16x16x64_bf16 v[64:67], v[44:47], v[68:75], v11
  s_waitcnt lgkmcnt(0)
  v_smfmac_f32_16x16x64_bf16 v[60:63], v[48:51], v[108:115], v11
  v_smfmac_f32_16x16x64_bf16 v[64:67], v[48:51], v[76:83], v11
  v_smfmac_f32_16x16x64_bf16 v[52:55], v[20:23], a[0:7], v11
  v_smfmac_f32_16x16x64_bf16 v[56:59], v[20:23], a[8:15], v11
  v_add_f32 v60, v60, v62
  v_add_f32 v61, v61, v63
  v_add_f32 v64, v64, v66
  v_add_f32 v65, v65, v67
  v_cvt_pk_bf16_f32 v60, v60, v64
  v_cvt_pk_bf16_f32 v61, v61, v65
  s_barrier
  ds_write_b32 v5, v60 offset:24576
  ds_write_b32 v5, v61 offset:24864
  v_smfmac_f32_16x16x64_bf16 v[52:55], v[24:27], a[16:23], v11
  v_smfmac_f32_16x16x64_bf16 v[56:59], v[24:27], a[24:31], v11
  v_smfmac_f32_16x16x64_bf16 v[52:55], v[28:31], a[32:39], v11
  v_smfmac_f32_16x16x64_bf16 v[56:59], v[28:31], a[40:47], v11
  s_waitcnt lgkmcnt(0)
  s_barrier
  v_bfe_u32 v100, v1, 8, 1
  v_lshl_add_u32 v100, v100, 5, v1
  v_add_u32 v100, s9, v100
  ds_read_b128 v[100:103], v100 offset:24576
  v_smfmac_f32_16x16x64_bf16 v[52:55], v[32:35], a[48:55], v11
  v_smfmac_f32_16x16x64_bf16 v[56:59], v[32:35], a[56:63], v11
  v_smfmac_f32_16x16x64_bf16 v[52:55], v[36:39], a[64:71], v11
  v_smfmac_f32_16x16x64_bf16 v[56:59], v[36:39], a[72:79], v11
  v_smfmac_f32_16x16x64_bf16 v[52:55], v[40:43], a[80:87], v11
  v_smfmac_f32_16x16x64_bf16 v[56:59], v[40:43], a[88:95], v11
  s_waitcnt lgkmcnt(0)
  buffer_store_dwordx4 v[100:103], v14, s[72:75], s25 offen sc1
  v_smfmac_f32_16x16x64_bf16 v[52:55], v[44:47], a[96:103], v11
  v_smfmac_f32_16x16x64_bf16 v[56:59], v[44:47], a[104:111], v11
  v_smfmac_f32_16x16x64_bf16 v[52:55], v[48:51], a[112:119], v11
  v_smfmac_f32_16x16x64_bf16 v[56:59], v[48:51], a[120:127], v11
  s_nop 3
  v_cvt_pk_bf16_f32 v52, v52, v53
  v_cvt_pk_bf16_f32 v53, v54, v55
  s_nop 1
  v_cvt_pk_bf16_f32 v54, v56, v57
  v_cvt_pk_bf16_f32 v55, v58, v59
  buffer_store_dwordx4 v[52:55], v1, s[72:75], s26 offen sc1
  s_endpgm
  s_nop 0
  s_nop 0
  s_nop 0
  s_nop 0
  s_nop 0
  s_nop 0
  s_nop 0
L_nrF:
  s_buffer_load_dword s48, s[72:75], s47 offset:8128
  s_buffer_load_dword s48, s[72:75], s47 offset:8064
  s_buffer_load_dword s48, s[72:75], s47 offset:8000
  s_buffer_load_dword s48, s[72:75], s47 offset:7936
  s_buffer_load_dword s48, s[72:75], s47 offset:7872
  s_buffer_load_dword s48, s[72:75], s47 offset:7808
  s_buffer_load_dword s48, s[72:75], s47 offset:7744
  s_buffer_load_dword s48, s[72:75], s47 offset:7680
  s_add_u32 m0, s44, 8192
  s_barrier
  buffer_load_dwordx4 v1, s[72:75], s23 offen offset:0 nt lds
  buffer_load_dwordx4 v1, s[72:75], s23 offen offset:1024 nt lds
  buffer_load_dwordx4 v1, s[72:75], s23 offen offset:2048 nt lds
  buffer_load_dwordx4 v1, s[72:75], s23 offen offset:3072 nt lds
  v_mov_b32 v43, -1
  buffer_store_dword v43, v9, s[72:75], s22 offen
  s_add_u32 s77, s12, 1
  v_mov_b32 v44, s77
  v_lshrrev_b32 v45, 2, v1
  ds_write_b32 v45, v44 offset:31744
  v_add_u32 v52, s43, v1
  v_lshrrev_b32 v53, 2, v1
  ds_write_b128 v52, v[100:103] offset:26880
  ds_read_b32 v52, v53 offset:31472
  s_add_u32 s20, s20, 0x2000
  s_and_b32 s20, s20, 0xffff7fff
  ds_read_b128 v[84:87], v2 offset:0
  ds_read_b128 v[88:91], v2 offset:1024
  ds_read_b128 v[92:95], v2 offset:2048
  ds_read_b128 v[96:99], v2 offset:3072
  ds_read_b128 v[68:71], v0 offset:16384
  ds_read_b128 v[72:75], v0 offset:17408
  ds_read_b128 v[76:79], v0 offset:18432
  ds_read_b128 v[80:83], v0 offset:19456
  ds_read_b128 v[116:119], v2 offset:16384
  ds_read_b128 v[120:123], v2 offset:17408
  ds_read_b128 v[108:111], v2 offset:18432
  ds_read_b128 v[112:115], v2 offset:19456
  s_waitcnt vmcnt(5)
  s_branch L_b2F
L_rednF:
  s_mov_b32 s14, 0
  s_mov_b64 exec, vcc
L_rednlF:
  buffer_load_dwordx4 v[20:23], v7, s[72:75], s17 offen offset:0 sc1
  buffer_load_dwordx4 v[24:27], v7, s[72:75], s17 offen offset:2048 sc1
  buffer_load_dwordx4 v[28:31], v7, s[72:75], s18 offen offset:0 sc1
  buffer_load_dwordx4 v[32:35], v7, s[72:75], s18 offen offset:2048 sc1
  s_add_u32 s14, s14, 1
  s_cmp_gt_u32 s14, 200000
  s_cbranch_scc1 L_end
  s_waitcnt vmcnt(12)
  v_bitop3_b32 v44, v20, v22, s21 bitop3:0x7e
  v_bitop3_b32 v45, v24, v26, s21 bitop3:0x7e
  v_bitop3_b32 v46, v28, v30, s21 bitop3:0x7e
  v_or3_b32 v44, v44, v45, v46
  v_and_b32 v44, 1, v44
  v_bitop3_b32 v47, v32, v34, s21 bitop3:0x7e
  v_and_or_b32 v44, v47, 1, v44
  v_cmp_ne_u32 vcc, 0, v44
  s_nop 0
  s_and_b64 exec, exec, vcc
  s_cbranch_scc1 L_rednlF
L_rednxF:
  s_mov_b64 exec, -1
  v_mfma_f32_16x16x32_bf16 v[48:51], v[36:39], v[20:23], 0
  v_mfma_f32_16x16x32_bf16 v[48:51], v[36:39], v[24:27], v[48:51]
  v_mfma_f32_16x16x32_bf16 v[48:51], v[36:39], v[28:31], v[48:51]
  v_mfma_f32_16x16x32_bf16 v[48:51], v[36:39], v[32:35], v[48:51]
  s_nop 4
  s_branch L_redokF
L_pm0F:
  s_mov_b32 s14, 0
  s_mov_b64 exec, vcc
L_pm0lF:
  buffer_load_dwordx4 v[20:23], v1, s[72:75], s20 offen offset:0 sc1
  s_add_u32 s14, s14, 1
  s_cmp_gt_u32 s14, 200000
  s_cbranch_scc1 L_end
  s_waitcnt vmcnt(12)
  v_max3_u32 v28, v20, v21, v22
  v_max_u32 v28, v28, v23
  v_cmp_eq_u32 vcc, -1, v28
  s_nop 0
  s_and_b64 exec, exec, vcc
  s_cbranch_scc1 L_pm0lF
L_pm0xF:
  s_mov_b64 exec, -1
  ds_write_b128 v3, v[20:23] offset:0
  s_cmp_lt_u32 s12, 63
  v_smfmac_f32_16x16x64_bf16 v[52:55], v[20:23], v[84:91], v11
  v_smfmac_f32_16x16x64_bf16 v[56:59], v[20:23], v[92:99], v11
  v_smfmac_f32_16x16x64_bf16 v[60:63], v[20:23], a[128:135], v11
  s_branch L_c1F
L_pm1F:
  s_mov_b32 s14, 0
  s_mov_b64 exec, vcc
L_pm1lF:
  buffer_load_dwordx4 v[24:27], v1, s[72:75], s20 offen offset:1024 sc1
  s_add_u32 s14, s14, 1
  s_cmp_gt_u32 s14, 200000
  s_cbranch_scc1 L_end
  s_waitcnt vmcnt(12)
  v_max3_u32 v28, v24, v25, v26
  v_max_u32 v28, v28, v27
  v_cmp_eq_u32 vcc, -1, v28
  s_nop 0
  s_and_b64 exec, exec, vcc
  s_cbranch_scc1 L_pm1lF
L_pm1xF:
  s_mov_b64 exec, -1
  ds_write_b128 v3, v[24:27] offset:1024
  s_cmp_lt_u32 s12, 63
  s_branch L_c2F
L_kvwF:
  v_and_b32 v41, 16, v1
  v_lshlrev_b32 v41, 3, v41
  s_mov_b32 s14, 0
L_kvp_6:
  buffer_load_dword v40, v41, s[72:75], s13 offen sc1
  s_add_u32 s14, s14, 1
  s_cmp_gt_u32 s14, 200000
  s_cbranch_scc1 L_end
  s_waitcnt vmcnt(0)
L_kvp_6c:
  v_lshlrev_b32 v40, 3, v40
  v_lshrrev_b32 v42, 5, v41
  v_add_u32 v40, v40, v42
  v_cmp_ge_u32 vcc, s76, v40
  s_nop 0
  s_and_b32 s10, vcc_lo, 3
  s_cbranch_scc1 L_kvp_6
  s_branch L_kvrF
L_oxF:
  s_mov_b32 s14, 0
L_oxlF:
  ds_read_b128 v[40:43], v125 offset:16384
  ds_read_b128 v[44:47], v126 offset:16384
  ds_read_b128 v[36:39], v127 offset:16384
  s_add_u32 s14, s14, 1
  s_cmp_gt_u32 s14, 200000
  s_cbranch_scc1 L_end
  s_waitcnt lgkmcnt(0)
  v_max3_u32 v48, v42, v46, v38
  v_cmp_eq_u32 vcc, -1, v48
  s_cbranch_vccnz L_oxlF
  v_mov_b64 v[20:21], 0
  v_mov_b64 v[22:23], 0
  v_mov_b64 v[24:25], 0
  v_mov_b64 v[26:27], 0
  v_mov_b64 v[28:29], 0
  v_mov_b64 v[30:31], 0
  v_mov_b64 v[32:33], 0
  v_mov_b64 v[34:35], 0
  v_smfmac_f32_16x16x64_bf16 v[20:23], v[60:63], v[176:183], v11
  v_smfmac_f32_16x16x64_bf16 v[24:27], v[60:63], v[192:199], v11
  v_smfmac_f32_16x16x64_bf16 v[28:31], v[60:63], v[208:215], v11
  v_smfmac_f32_16x16x64_bf16 v[32:35], v[60:63], v[224:231], v11
  v_smfmac_f32_16x16x64_bf16 v[20:23], v[40:43], v[184:191], v11
  v_smfmac_f32_16x16x64_bf16 v[20:23], v[44:47], v[240:247], v11
  v_smfmac_f32_16x16x64_bf16 v[20:23], v[36:39], v[248:255], v11
  v_smfmac_f32_16x16x64_bf16 v[24:27], v[40:43], v[200:207], v11
  v_smfmac_f32_16x16x64_bf16 v[24:27], v[44:47], v[68:75], v11
  v_cvt_pk_bf16_f32 v20, v20, v22
  v_smfmac_f32_16x16x64_bf16 v[24:27], v[36:39], v[76:83], v11
  s_branch L_oxretF
L_fbF:
  s_waitcnt lgkmcnt(0)
  s_sub_u32 s76, s23, s44
  s_sub_u32 s76, s76, 0x80000
  s_add_u32 s14, s76, 4096
  buffer_load_dwordx4 v[20:23], v1, s[72:75], s76 offen offset:0 sc1
  s_nop 0
  buffer_load_dwordx4 v[24:27], v1, s[72:75], s76 offen offset:1024 sc1
  buffer_load_dwordx4 v[28:31], v1, s[72:75], s76 offen offset:2048 sc1
  buffer_load_dwordx4 v[32:35], v1, s[72:75], s76 offen offset:3072 sc1
  buffer_load_dwordx4 v[36:39], v1, s[72:75], s14 offen offset:0 sc1
  buffer_load_dwordx4 v[40:43], v1, s[72:75], s14 offen offset:1024 sc1
  buffer_load_dwordx4 v[44:47], v1, s[72:75], s14 offen offset:2048 sc1
  buffer_load_dwordx4 v[48:51], v1, s[72:75], s14 offen offset:3072 sc1
  ds_read_b128 v[68:71], v6 offset:26880
  ds_read_b128 v[72:75], v6 offset:26944
  ds_read_b128 v[76:79], v6 offset:27008
  ds_read_b128 v[80:83], v6 offset:27072
  ds_read_b128 v[84:87], v6 offset:24576
  ds_read_b128 v[88:91], v6 offset:24640
  ds_read_b128 v[92:95], v6 offset:24704
  ds_read_b128 v[96:99], v6 offset:24768
  s_waitcnt vmcnt(0) lgkmcnt(0)
  v_mfma_f32_16x16x32_bf16 v[116:119], v[20:23], v[68:71], 0
  v_mfma_f32_16x16x32_bf16 v[116:119], v[24:27], v[72:75], v[116:119]
  v_mfma_f32_16x16x32_bf16 v[116:119], v[28:31], v[76:79], v[116:119]
  v_mfma_f32_16x16x32_bf16 v[116:119], v[32:35], v[80:83], v[116:119]
  v_mfma_f32_16x16x32_bf16 v[120:123], v[36:39], v[68:71], 0
  v_mfma_f32_16x16x32_bf16 v[120:123], v[40:43], v[72:75], v[120:123]
  v_mfma_f32_16x16x32_bf16 v[120:123], v[44:47], v[76:79], v[120:123]
  v_mfma_f32_16x16x32_bf16 v[120:123], v[48:51], v[80:83], v[120:123]
  v_mfma_f32_16x16x32_bf16 v[36:39], v[84:87], v[68:71], 0
  v_mfma_f32_16x16x32_bf16 v[36:39], v[88:91], v[72:75], v[36:39]
  v_mfma_f32_16x16x32_bf16 v[36:39], v[92:95], v[76:79], v[36:39]
  v_mfma_f32_16x16x32_bf16 v[36:39], v[96:99], v[80:83], v[36:39]
  s_nop 7
  v_mul_f32 v36, s28, v36
  v_mul_f32 v37, s28, v37
  v_max3_f32 v40, v116, v117, v118
  v_max3_f32 v40, v40, v119, v120
  v_max3_f32 v40, v40, v121, v122
  v_max3_f32 v40, v40, v123, v36
  v_max_f32 v40, v40, v37
  v_mov_b32 v41, v40
  s_nop 1
  v_permlane16_swap_b32 v40, v41
  v_max_f32 v40, v40, v41
  v_mov_b32 v41, v40
  s_nop 1
  v_permlane32_swap_b32 v40, v41
  v_max_f32 v40, v40, v41
  v_sub_f32 v116, v116, v40
  v_exp_f32 v116, v116
  v_sub_f32 v117, v117, v40
  v_exp_f32 v117, v117
  v_sub_f32 v118, v118, v40
  v_exp_f32 v118, v118
  v_sub_f32 v119, v119, v40
  v_exp_f32 v119, v119
  v_sub_f32 v120, v120, v40
  v_exp_f32 v120, v120
  v_sub_f32 v121, v121, v40
  v_exp_f32 v121, v121
  v_sub_f32 v122, v122, v40
  v_exp_f32 v122, v122
  v_sub_f32 v123, v123, v40
  v_exp_f32 v123, v123
  v_sub_f32 v36, v36, v40
  v_exp_f32 v36, v36
  v_sub_f32 v37, v37, v40
  v_exp_f32 v37, v37
  v_cvt_pk_bf16_f32 v116, v116, v117
  v_cvt_pk_bf16_f32 v117, v118, v119
  v_cvt_pk_bf16_f32 v118, v120, v121
  v_cvt_pk_bf16_f32 v119, v122, v123
  v_cvt_pk_bf16_f32 v14, v36, v37
  v_cvt_pk_bf16_f32 v15, v36, v37
  v_mfma_f32_16x16x32_bf16 v[52:55], v[16:19], v[116:119], 0
  v_mfma_f32_16x16x32_bf16 v[60:63], v[56:59], v[116:119], 0
  v_mfma_f32_16x16x32_bf16 v[64:67], v[108:111], v[116:119], 0
  v_mfma_f32_16x16x16_bf16 v[52:55], v[12:13], v[14:15], v[52:55]
  v_mfma_f32_16x16x16_bf16 v[60:63], v[100:101], v[14:15], v[60:63]
  v_mfma_f32_16x16x16_bf16 v[64:67], v[102:103], v[14:15], v[64:67]
  ds_read_b128 v[68:71], v0 offset:32768
  ds_read_b128 v[72:75], v0 offset:33792
  v_mov_b64 v[20:21], 0
  v_mov_b64 v[22:23], 0
  v_mov_b64 v[24:25], 0
  v_mov_b64 v[26:27], 0
  v_mov_b64 v[28:29], 0
  v_mov_b64 v[30:31], 0
  v_mov_b64 v[32:33], 0
  v_mov_b64 v[34:35], 0
  v_rcp_f32 v55, v54
  s_nop 0
  v_mul_f32 v60, v55, v60
  v_mul_f32 v61, v55, v61
  v_mul_f32 v62, v55, v62
  v_mul_f32 v63, v55, v63
  v_cvt_pk_bf16_f32 v60, v60, v61
  v_cvt_pk_bf16_f32 v61, v62, v63
  v_mul_f32 v64, v55, v64
  v_mul_f32 v65, v55, v65
  v_mul_f32 v66, v55, v66
  v_mul_f32 v67, v55, v67
  v_cvt_pk_bf16_f32 v62, v64, v65
  v_cvt_pk_bf16_f32 v63, v66, v67
  ds_write_b128 v3, v[60:63] offset:16384
  s_waitcnt lgkmcnt(0)
  s_barrier
  ds_read_b128 v[40:43], v125 offset:16384
  ds_read_b128 v[44:47], v126 offset:16384
  ds_read_b128 v[36:39], v127 offset:16384
  v_smfmac_f32_16x16x64_bf16 v[20:23], v[60:63], v[176:183], v11
  v_smfmac_f32_16x16x64_bf16 v[24:27], v[60:63], v[192:199], v11
  v_mov_b32 v14, s38
  s_waitcnt lgkmcnt(0)
  s_branch L_fbretF
L_topS:
  s_add_u32 m0, s78, 16384
  s_xor_b32 s17, s17, 0x40000
  buffer_load_dwordx4 v1, s[72:75], s24 offen offset:0 nt lds
  buffer_load_dwordx4 v1, s[72:75], s24 offen offset:1024 nt lds
  s_mov_b32 m0, s91
  s_xor_b32 s18, s18, 0x40000
  s_add_u32 s19, s19, 0x2000
  s_and_b32 s19, s19, 0xffff7fff
  s_add_u32 s22, s22, 0x2000
  s_and_b32 s22, s22, 0xffff7fff
  s_add_u32 s77, s12, 2
  s_min_u32 s77, s77, 63
  s_lshl_b32 s76, s77, 2
  s_add_u32 s12, s12, 1
  s_xor_b32 s15, s15, 0x40000
  s_add_u32 s25, s25, s26
  s_lshl_b32 s77, s77, 19
  s_add_u32 s77, s77, s7
  s_mov_b32 s47, s77
  s_add_u32 s23, s23, 524288
  s_add_u32 s24, s24, 524288
  v_mov_b64 v[60:61], 0
  v_mov_b64 v[62:63], 0
  v_mov_b64 v[64:65], 0
  v_mov_b64 v[66:67], 0
  buffer_load_dwordx4 v[20:23], v1, s[72:75], s20 offen offset:0 sc1
  v_mov_b64 v[100:101], 0
  v_mov_b64 v[102:103], 0
  v_mov_b64 v[104:105], 0
  v_mov_b64 v[106:107], 0
  s_bfe_u32 s21, s12, 0x10001
  s_add_u32 s38, s12, 1
  v_lshrrev_b32 v14, 2, v1
  v_add_u32 v15, s42, v14
  v_add_u32 v14, s25, v14
  v_cndmask_b32_e64 v14, 2.0, v14, s[40:41]
  v_lshl_add_u32 v40, v1, 3, s77
  v_and_b32 v41, 16, v1
  v_lshl_add_u32 v41, v41, 3, s13
  v_cndmask_b32_e64 v4, v41, v40, s[30:31]
  s_waitcnt lgkmcnt(0)
  v_mad_u32_u24 v52, v52, 8, v53
  v_cmp_ge_u32 vcc, s76, v52
  buffer_load_dwordx4 v[24:27], v1, s[72:75], s20 offen offset:1024 sc1
  s_and_b32 s8, vcc_lo, 3
  s_cbranch_scc1 L_kvwS
L_kvrS:
  v_mov_b64 v[52:53], 0
  v_mov_b64 v[54:55], 0
  v_mov_b64 v[56:57], 0
  v_mov_b64 v[58:59], 0
  s_cmp_lt_u32 s12, 63
  s_waitcnt vmcnt(1)
  v_max3_u32 v28, v20, v21, v22
  v_max_u32 v28, v28, v23
  v_cmp_eq_u32 vcc, -1, v28
  ds_write_b128 v3, v[20:23] offset:0
  s_cbranch_vccnz L_pm0S
  v_smfmac_f32_16x16x64_bf16 v[52:55], v[20:23], v[84:91], v11
  v_smfmac_f32_16x16x64_bf16 v[56:59], v[20:23], v[92:99], v11
  v_smfmac_f32_16x16x64_bf16 v[60:63], v[20:23], a[128:135], v11
  s_waitcnt vmcnt(0)
L_c1S:
  ds_write_b128 v3, v[24:27] offset:1024
  v_max3_u32 v28, v24, v25, v26
  v_max_u32 v28, v28, v27
  v_cmp_eq_u32 vcc, -1, v28
  v_smfmac_f32_16x16x64_bf16 v[64:67], v[20:23], a[136:143], v11
  v_smfmac_f32_16x16x64_bf16 v[100:103], v[20:23], a[0:7], v11
  s_cbranch_vccnz L_pm1S
L_c2S:
  s_cbranch_scc0 L_tail
  v_smfmac_f32_16x16x64_bf16 v[104:107], v[20:23], a[8:15], v11
  s_waitcnt lgkmcnt(0)
  s_barrier
L_stepS:
  ds_read_b128 v[28:31], v125 offset:0
  v_smfmac_f32_16x16x64_bf16 v[52:55], v[24:27], v[68:75], v11
  buffer_load_dword v4, s[72:75], 0 offen sc1 lds
  v_smfmac_f32_16x16x64_bf16 v[56:59], v[24:27], v[76:83], v11
  ds_read_b128 v[32:35], v125 offset:1024
  v_smfmac_f32_16x16x64_bf16 v[60:63], v[24:27], a[144:151], v11
  ds_read_b128 v[36:39], v126 offset:0
  v_smfmac_f32_16x16x64_bf16 v[64:67], v[24:27], a[152:159], v11
  ds_read_b128 v[40:43], v126 offset:1024
  v_smfmac_f32_16x16x64_bf16 v[100:103], v[24:27], a[16:23], v11
  ds_read_b128 v[44:47], v127 offset:0
  v_smfmac_f32_16x16x64_bf16 v[104:107], v[24:27], a[24:31], v11
  ds_read_b128 v[48:51], v127 offset:1024
  s_waitcnt lgkmcnt(5)
  v_smfmac_f32_16x16x64_bf16 v[52:55], v[28:31], v[116:123], v11
  ds_read_b32 v124, v15
  v_smfmac_f32_16x16x64_bf16 v[56:59], v[28:31], v[108:115], v11
  ds_read_b128 v[68:71], v0 offset:51200
  s_waitcnt lgkmcnt(6)
  v_smfmac_f32_16x16x64_bf16 v[52:55], v[32:35], a[224:231], v11
  ds_read_b128 v[72:75], v0 offset:52224
  v_smfmac_f32_16x16x64_bf16 v[56:59], v[32:35], a[232:239], v11
  ds_read_b128 v[76:79], v0 offset:2048
  s_waitcnt lgkmcnt(7)
  v_smfmac_f32_16x16x64_bf16 v[52:55], v[36:39], a[240:247], v11
  ds_read_b128 v[80:83], v0 offset:3072
  v_smfmac_f32_16x16x64_bf16 v[56:59], v[36:39], a[248:255], v11
  s_waitcnt lgkmcnt(4)
  buffer_store_dword v124, v14, s[72:75], 0 offen sc1
  v_smfmac_f32_16x16x64_bf16 v[52:55], v[40:43], v[128:135], v11
  ds_read_b128 v[116:119], v0 offset:49152
  v_smfmac_f32_16x16x64_bf16 v[56:59], v[40:43], v[136:143], v11
  ds_read_b128 v[120:123], v0 offset:50176
  v_smfmac_f32_16x16x64_bf16 v[52:55], v[44:47], v[144:151], v11
  ds_read_b128 v[108:111], v0 offset:0
  v_smfmac_f32_16x16x64_bf16 v[56:59], v[44:47], v[152:159], v11
  ds_read_b128 v[112:115], v0 offset:1024
  v_smfmac_f32_16x16x64_bf16 v[52:55], v[48:51], v[160:167], v11
  v_smfmac_f32_16x16x64_bf16 v[56:59], v[48:51], v[168:175], v11
  v_smfmac_f32_16x16x64_bf16 v[60:63], v[28:31], a[160:167], v11
  ds_read_b128 v[84:87], v1 offset:8192
  v_add_f32 v52, v52, v54
  v_smfmac_f32_16x16x64_bf16 v[64:67], v[28:31], a[168:175], v11
  ds_read_b128 v[88:91], v1 offset:9216
  v_add_f32 v53, v53, v55
  v_smfmac_f32_16x16x64_bf16 v[60:63], v[32:35], a[176:183], v11
  ds_read_b128 v[92:95], v1 offset:10240
  v_add_f32 v56, v56, v58
  v_smfmac_f32_16x16x64_bf16 v[64:67], v[32:35], a[184:191], v11
  ds_read_b128 v[96:99], v1 offset:11264
  v_add_f32 v57, v57, v59
  v_smfmac_f32_16x16x64_bf16 v[60:63], v[36:39], a[192:199], v11
  v_cvt_pk_bf16_f32 v52, v52, v56
  v_smfmac_f32_16x16x64_bf16 v[64:67], v[36:39], a[200:207], v11
  v_cvt_pk_bf16_f32 v53, v53, v57
  v_smfmac_f32_16x16x64_bf16 v[60:63], v[40:43], a[208:215], v11
  ds_write_b32 v5, v52 offset:26880
  v_smfmac_f32_16x16x64_bf16 v[64:67], v[40:43], a[216:223], v11
  s_waitcnt lgkmcnt(7)
  ds_write_b32 v5, v53 offset:27168
  v_mov_b32 v15, -1
  v_smfmac_f32_16x16x64_bf16 v[60:63], v[44:47], v[116:123], v11
  s_waitcnt vmcnt(2)
  v_mov_b64 v[20:21], 0
  v_smfmac_f32_16x16x64_bf16 v[64:67], v[44:47], v[68:75], v11
  s_waitcnt lgkmcnt(6)
  ds_read_b128 v[52:55], v1 offset:12288
  v_mov_b64 v[22:23], 0
  v_smfmac_f32_16x16x64_bf16 v[60:63], v[48:51], v[108:115], v11
  ds_read_b128 v[56:59], v1 offset:13312
  v_mov_b64 v[24:25], 0
  v_smfmac_f32_16x16x64_bf16 v[64:67], v[48:51], v[76:83], v11
  v_mov_b64 v[26:27], 0
  v_smfmac_f32_16x16x64_bf16 v[100:103], v[28:31], a[32:39], v11
  s_waitcnt lgkmcnt(2)
  s_barrier
  ds_read_b128 v[68:71], v6 offset:26880
  v_add_f32 v60, v60, v62
  v_smfmac_f32_16x16x64_bf16 v[104:107], v[28:31], a[40:47], v11
  ds_read_b128 v[72:75], v6 offset:26944
  v_add_f32 v61, v61, v63
  v_smfmac_f32_16x16x64_bf16 v[100:103], v[32:35], a[48:55], v11
  ds_read_b128 v[76:79], v6 offset:27008
  v_add_f32 v64, v64, v66
  v_smfmac_f32_16x16x64_bf16 v[104:107], v[32:35], a[56:63], v11
  ds_read_b128 v[80:83], v6 offset:27072
  v_add_f32 v65, v65, v67
  v_smfmac_f32_16x16x64_bf16 v[100:103], v[36:39], a[64:71], v11
  ds_read_b128 v[108:111], v1 offset:14336
  v_cvt_pk_bf16_f32 v60, v60, v64
  v_smfmac_f32_16x16x64_bf16 v[104:107], v[36:39], a[72:79], v11
  s_waitcnt lgkmcnt(4)
  ds_read_b128 v[112:115], v1 offset:15360
  v_cvt_pk_bf16_f32 v61, v61, v65
  v_mfma_f32_16x16x32_bf16 v[116:119], v[84:87], v[68:71], 0
  ds_write_b32 v5, v60 offset:24576
  s_waitcnt lgkmcnt(5)
  v_mfma_f32_16x16x32_bf16 v[116:119], v[88:91], v[72:75], v[116:119]
  s_waitcnt lgkmcnt(4)
  ds_write_b32 v5, v61 offset:24864
  v_mov_b64 v[28:29], 0
  v_mfma_f32_16x16x32_bf16 v[116:119], v[92:95], v[76:79], v[116:119]
  s_waitcnt lgkmcnt(4)
  v_mov_b64 v[30:31], 0
  v_mfma_f32_16x16x32_bf16 v[116:119], v[96:99], v[80:83], v[116:119]
  v_mov_b64 v[32:33], 0
  v_mfma_f32_16x16x32_bf16 v[120:123], v[52:55], v[68:71], 0
  v_mov_b64 v[34:35], 0
  v_mfma_f32_16x16x32_bf16 v[120:123], v[56:59], v[72:75], v[120:123]
  s_waitcnt lgkmcnt(3)
  v_exp_f32 v116, v116
  v_mfma_f32_16x16x32_bf16 v[120:123], v[108:111], v[76:79], v[120:123]
  s_waitcnt lgkmcnt(2)
  s_waitcnt lgkmcnt(0)
  s_barrier
  v_exp_f32 v117, v117
  v_mfma_f32_16x16x32_bf16 v[120:123], v[112:115], v[80:83], v[120:123]
  v_exp_f32 v118, v118
  v_smfmac_f32_16x16x64_bf16 v[100:103], v[40:43], a[80:87], v11
  ds_read_b128 v[84:87], v6 offset:24576
  v_exp_f32 v119, v119
  v_smfmac_f32_16x16x64_bf16 v[104:107], v[40:43], a[88:95], v11
  ds_read_b128 v[88:91], v6 offset:24640
  v_cvt_pk_bf16_f32 v116, v116, v117
  v_smfmac_f32_16x16x64_bf16 v[100:103], v[44:47], a[96:103], v11
  ds_read_b128 v[92:95], v6 offset:24704
  v_cvt_pk_bf16_f32 v117, v118, v119
  v_smfmac_f32_16x16x64_bf16 v[104:107], v[44:47], a[104:111], v11
  ds_read_b128 v[96:99], v6 offset:24768
  v_exp_f32 v120, v120
  v_smfmac_f32_16x16x64_bf16 v[100:103], v[48:51], a[112:119], v11
  ds_read_b128 v[56:59], v3 offset:16384
  ds_read_b128 v[108:111], v3 offset:17408
  s_waitcnt lgkmcnt(5)
  v_mfma_f32_16x16x32_bf16 v[36:39], v[84:87], v[68:71], 0
  s_waitcnt lgkmcnt(4)
  v_exp_f32 v121, v121
  v_mfma_f32_16x16x32_bf16 v[36:39], v[88:91], v[72:75], v[36:39]
  s_waitcnt lgkmcnt(3)
  v_exp_f32 v122, v122
  v_mfma_f32_16x16x32_bf16 v[36:39], v[92:95], v[76:79], v[36:39]
  s_waitcnt lgkmcnt(2)
  v_exp_f32 v123, v123
  v_mfma_f32_16x16x32_bf16 v[36:39], v[96:99], v[80:83], v[36:39]
  v_cvt_pk_bf16_f32 v118, v120, v121
  v_cvt_pk_bf16_f32 v119, v122, v123
  v_smfmac_f32_16x16x64_bf16 v[104:107], v[48:51], a[120:127], v11
  ds_write_b32 v3, v15 offset:16392
  v_mfma_f32_16x16x32_bf16 v[52:55], v[16:19], v[116:119], 0
  s_waitcnt lgkmcnt(1)
  v_mul_f32 v36, s28, v36
  v_mul_f32 v37, s28, v37
  v_mfma_f32_16x16x32_bf16 v[60:63], v[56:59], v[116:119], 0
  v_exp_f32 v36, v36
  v_mfma_f32_16x16x32_bf16 v[64:67], v[108:111], v[116:119], 0
  s_waitcnt lgkmcnt(0)
  v_exp_f32 v37, v37
  v_cvt_pk_bf16_f32 v100, v100, v101
  v_cvt_pk_bf16_f32 v14, v36, v37
  v_cvt_pk_bf16_f32 v15, v36, v37
  v_cvt_pk_bf16_f32 v101, v102, v103
  v_cvt_pk_bf16_f32 v102, v104, v105
  v_mfma_f32_16x16x16_bf16 v[52:55], v[12:13], v[14:15], v[52:55]
  ds_read_b128 v[68:71], v0 offset:32768
  v_cvt_pk_bf16_f32 v103, v106, v107
  v_mfma_f32_16x16x16_bf16 v[60:63], v[100:101], v[14:15], v[60:63]
  ds_read_b128 v[72:75], v0 offset:33792
  v_mfma_f32_16x16x16_bf16 v[64:67], v[102:103], v[14:15], v[64:67]
  v_rcp_f32 v55, v54
  v_subrev_u32 v53, s29, v54
  v_cmp_le_u32 vcc, s79, v53
  s_nop 0
  v_mul_f32 v60, v55, v60
  v_mul_f32 v61, v55, v61
  v_mul_f32 v62, v55, v62
  v_mul_f32 v63, v55, v63
  v_cvt_pk_bf16_f32 v60, v60, v61
  v_cvt_pk_bf16_f32 v61, v62, v63
  ds_write_b64 v3, v[60:61] offset:16384
  v_mul_f32 v64, v55, v64
  v_mul_f32 v65, v55, v65
  v_mul_f32 v66, v55, v66
  v_mul_f32 v67, v55, v67
  v_cvt_pk_bf16_f32 v62, v64, v65
  v_cvt_pk_bf16_f32 v63, v66, v67
  ds_write_b64 v3, v[62:63] offset:16392
  s_nop 0
  v_smfmac_f32_16x16x64_bf16 v[20:23], v[60:63], v[176:183], v11
  s_barrier
  ds_read_b128 v[40:43], v125 offset:16384
  ds_read_b128 v[44:47], v126 offset:16384
  ds_read_b128 v[36:39], v127 offset:16384
  v_smfmac_f32_16x16x64_bf16 v[24:27], v[60:63], v[192:199], v11
  s_cbranch_vccnz L_fbS
L_fbretS:
  v_smfmac_f32_16x16x64_bf16 v[28:31], v[60:63], v[208:215], v11
  ds_read_b128 v[76:79], v0 offset:34816
  ds_read_b128 v[80:83], v0 offset:35840
  v_smfmac_f32_16x16x64_bf16 v[32:35], v[60:63], v[224:231], v11
  ds_read_b128 v[84:87], v2 offset:32768
  ds_read_b128 v[88:91], v2 offset:33792
  s_waitcnt lgkmcnt(6)
  v_smfmac_f32_16x16x64_bf16 v[20:23], v[40:43], v[184:191], v11
  ds_read_b128 v[92:95], v2 offset:34816
  s_waitcnt lgkmcnt(6)
  v_smfmac_f32_16x16x64_bf16 v[20:23], v[44:47], v[240:247], v11
  ds_read_b128 v[96:99], v2 offset:35840
  s_waitcnt lgkmcnt(6)
  v_smfmac_f32_16x16x64_bf16 v[20:23], v[36:39], v[248:255], v11
  ds_read_b128 v[116:119], v2 offset:49152
  ds_read_b128 v[120:123], v2 offset:50176
  v_max3_u32 v48, v42, v46, v38
  v_smfmac_f32_16x16x64_bf16 v[24:27], v[40:43], v[200:207], v11
  v_cmp_eq_u32 vcc, -1, v48
  v_smfmac_f32_16x16x64_bf16 v[24:27], v[44:47], v[68:75], v11
  s_waitcnt lgkmcnt(6)
  ds_read_b128 v[108:111], v2 offset:51200
  ds_read_b128 v[112:115], v2 offset:52224
  v_cvt_pk_bf16_f32 v20, v20, v22
  v_smfmac_f32_16x16x64_bf16 v[24:27], v[36:39], v[76:83], v11
  s_cbranch_vccnz L_oxS
L_oxretS:
  v_cvt_pk_bf16_f32 v21, v21, v23
  v_smfmac_f32_16x16x64_bf16 v[28:31], v[40:43], v[216:223], v11
  s_waitcnt lgkmcnt(6)
  v_and_or_b32 v20, v20, -2, s21
  v_smfmac_f32_16x16x64_bf16 v[28:31], v[44:47], v[84:91], v11
  s_waitcnt lgkmcnt(4)
  buffer_store_dwordx2 v[20:21], v8, s[72:75], s15 offen offset:0 sc1
  v_cvt_pk_bf16_f32 v24, v24, v26
  v_smfmac_f32_16x16x64_bf16 v[28:31], v[36:39], v[92:99], v11
  v_cvt_pk_bf16_f32 v25, v25, v27
  v_smfmac_f32_16x16x64_bf16 v[32:35], v[40:43], v[232:239], v11
  s_waitcnt lgkmcnt(2)
  s_cmp_lg_u32 s4, 1
  v_and_or_b32 v24, v24, -2, s21
  v_smfmac_f32_16x16x64_bf16 v[32:35], v[44:47], v[116:123], v11
  s_waitcnt lgkmcnt(0)
  buffer_store_dwordx2 v[24:25], v8, s[72:75], s15 offen offset:64 sc1
  v_cvt_pk_bf16_f32 v28, v28, v30
  v_smfmac_f32_16x16x64_bf16 v[32:35], v[36:39], v[108:115], v11
  v_cvt_pk_bf16_f32 v29, v29, v31
  v_and_or_b32 v28, v28, -2, s21
  buffer_store_dwordx2 v[28:29], v8, s[72:75], s15 offen offset:128 sc1
  s_nop 4
  v_cvt_pk_bf16_f32 v32, v32, v34
  v_cvt_pk_bf16_f32 v33, v33, v35
  v_and_or_b32 v32, v32, -2, s21
  buffer_store_dwordx2 v[32:33], v8, s[72:75], s15 offen offset:192 sc1
  s_barrier
  s_cbranch_scc1 L_othS
  v_mov_b64 v[36:37], 0
  v_mov_b64 v[38:39], 0
  v_add_u32 v52, s43, v1
  v_lshrrev_b32 v53, 2, v1
  ds_write_b128 v52, v[100:103] offset:26880
  ds_read_b32 v52, v53 offset:31472
  s_add_u32 s20, s20, 0x2000
  s_and_b32 s20, s20, 0xffff7fff
  v_mov_b32_dpp v36, v16 quad_perm:[0,1,2,3] row_mask:0xf bank_mask:0x1
  v_mov_b32_dpp v37, v16 quad_perm:[0,1,2,3] row_mask:0xf bank_mask:0x2
  v_mov_b32_dpp v38, v16 quad_perm:[0,1,2,3] row_mask:0xf bank_mask:0x4
  v_mov_b32_dpp v39, v16 quad_perm:[0,1,2,3] row_mask:0xf bank_mask:0x8
  ds_read_b128 v[84:87], v2 offset:0
  ds_read_b128 v[88:91], v2 offset:1024
  ds_read_b128 v[92:95], v2 offset:2048
  ds_read_b128 v[96:99], v2 offset:3072
  ds_read_b128 v[68:71], v0 offset:16384
  ds_read_b128 v[72:75], v0 offset:17408
  ds_read_b128 v[76:79], v0 offset:18432
  ds_read_b128 v[80:83], v0 offset:19456
  ds_read_b128 v[116:119], v2 offset:16384
  ds_read_b128 v[120:123], v2 offset:17408
  ds_read_b128 v[108:111], v2 offset:18432
  ds_read_b128 v[112:115], v2 offset:19456
  s_nop 7
  s_nop 3
  buffer_load_dwordx4 v[20:23], v7, s[72:75], s17 offen offset:0 sc1
  buffer_load_dwordx4 v[24:27], v7, s[72:75], s17 offen offset:2048 sc1
  buffer_load_dwordx4 v[28:31], v7, s[72:75], s18 offen offset:0 sc1
  buffer_load_dwordx4 v[32:35], v7, s[72:75], s18 offen offset:2048 sc1
  s_barrier
  s_nop 0
L_rwS:
  s_waitcnt vmcnt(3)
  v_mfma_f32_16x16x32_bf16 v[48:51], v[36:39], v[20:23], 0
  v_bitop3_b32 v44, v20, v22, s21 bitop3:0x7e
  s_waitcnt vmcnt(2)
  v_mfma_f32_16x16x32_bf16 v[48:51], v[36:39], v[24:27], v[48:51]
  v_bitop3_b32 v45, v24, v26, s21 bitop3:0x7e
  s_waitcnt vmcnt(1)
  v_mfma_f32_16x16x32_bf16 v[48:51], v[36:39], v[28:31], v[48:51]
  v_bitop3_b32 v46, v28, v30, s21 bitop3:0x7e
  v_or3_b32 v44, v44, v45, v46
  v_and_b32 v44, 1, v44
  s_waitcnt vmcnt(0)
  v_mfma_f32_16x16x32_bf16 v[48:51], v[36:39], v[32:35], v[48:51]
  v_bitop3_b32 v47, v32, v34, s21 bitop3:0x7e
  v_and_or_b32 v44, v47, 1, v44
  v_cmp_ne_u32 vcc, 0, v44
L_redokS:
  s_nop 4
  v_add_f32_dpp v48, v48, v48 row_ror:8 row_mask:0xf bank_mask:0xf
  v_add_f32_dpp v49, v49, v49 row_ror:8 row_mask:0xf bank_mask:0xf
  s_cbranch_vccnz L_rednS
  v_cvt_pk_bf16_f32 v40, v48, v49
  buffer_store_dword v40, v9, s[72:75], s19 offen sc1
L_b2S:
  s_barrier
  s_branch L_topS
L_othS:
  s_cmp_lg_u32 s4, 0
  s_cbranch_scc1 L_nrS
  v_mov_b64 v[36:37], 0
  v_mov_b64 v[38:39], 0
  v_add_u32 v52, s43, v1
  v_lshrrev_b32 v53, 2, v1
  ds_write_b128 v52, v[100:103] offset:26880
  ds_read_b32 v52, v53 offset:31472
  s_add_u32 s20, s20, 0x2000
  s_and_b32 s20, s20, 0xffff7fff
  v_mov_b32_dpp v36, v16 quad_perm:[0,1,2,3] row_mask:0xf bank_mask:0x1
  v_mov_b32_dpp v37, v16 quad_perm:[0,1,2,3] row_mask:0xf bank_mask:0x2
  v_mov_b32_dpp v38, v16 quad_perm:[0,1,2,3] row_mask:0xf bank_mask:0x4
  v_mov_b32_dpp v39, v16 quad_perm:[0,1,2,3] row_mask:0xf bank_mask:0x8
  buffer_load_dwordx4 v[20:23], v7, s[72:75], s17 offen offset:0 sc1
  buffer_load_dwordx4 v[24:27], v7, s[72:75], s17 offen offset:2048 sc1
  buffer_load_dwordx4 v[28:31], v7, s[72:75], s18 offen offset:0 sc1
  buffer_load_dwordx4 v[32:35], v7, s[72:75], s18 offen offset:2048 sc1
  ds_read_b128 v[84:87], v2 offset:0
  ds_read_b128 v[88:91], v2 offset:1024
  ds_read_b128 v[92:95], v2 offset:2048
  ds_read_b128 v[96:99], v2 offset:3072
  ds_read_b128 v[68:71], v0 offset:16384
  ds_read_b128 v[72:75], v0 offset:17408
  s_barrier
  ds_read_b128 v[76:79], v0 offset:18432
  ds_read_b128 v[80:83], v0 offset:19456
  ds_read_b128 v[116:119], v2 offset:16384
  ds_read_b128 v[120:123], v2 offset:17408
  ds_read_b128 v[108:111], v2 offset:18432
  ds_read_b128 v[112:115], v2 offset:19456
  s_branch L_rwS
L_nrS:
  s_buffer_load_dword s48, s[72:75], s47 offset:8128
  s_buffer_load_dword s48, s[72:75], s47 offset:8064
  s_buffer_load_dword s48, s[72:75], s47 offset:8000
  s_buffer_load_dword s48, s[72:75], s47 offset:7936
  s_buffer_load_dword s48, s[72:75], s47 offset:7872
  s_buffer_load_dword s48, s[72:75], s47 offset:7808
  s_buffer_load_dword s48, s[72:75], s47 offset:7744
  s_buffer_load_dword s48, s[72:75], s47 offset:7680
  s_add_u32 m0, s44, 8192
  s_barrier
  buffer_load_dwordx4 v1, s[72:75], s23 offen offset:0 nt lds
  buffer_load_dwordx4 v1, s[72:75], s23 offen offset:1024 nt lds
  buffer_load_dwordx4 v1, s[72:75], s23 offen offset:2048 nt lds
  buffer_load_dwordx4 v1, s[72:75], s23 offen offset:3072 nt lds
  v_mov_b32 v43, -1
  buffer_store_dword v43, v9, s[72:75], s22 offen sc1
  s_add_u32 s77, s12, 1
  v_mov_b32 v44, s77
  v_lshrrev_b32 v45, 2, v1
  ds_write_b32 v45, v44 offset:31744
  v_add_u32 v52, s43, v1
  v_lshrrev_b32 v53, 2, v1
  ds_write_b128 v52, v[100:103] offset:26880
  ds_read_b32 v52, v53 offset:31472
  s_add_u32 s20, s20, 0x2000
  s_and_b32 s20, s20, 0xffff7fff
  ds_read_b128 v[84:87], v2 offset:0
  ds_read_b128 v[88:91], v2 offset:1024
  ds_read_b128 v[92:95], v2 offset:2048
  ds_read_b128 v[96:99], v2 offset:3072
  ds_read_b128 v[68:71], v0 offset:16384
  ds_read_b128 v[72:75], v0 offset:17408
  ds_read_b128 v[76:79], v0 offset:18432
  ds_read_b128 v[80:83], v0 offset:19456
  ds_read_b128 v[116:119], v2 offset:16384
  ds_read_b128 v[120:123], v2 offset:17408
  ds_read_b128 v[108:111], v2 offset:18432
  ds_read_b128 v[112:115], v2 offset:19456
  s_waitcnt vmcnt(5)
  s_branch L_b2S
L_rednS:
  s_mov_b32 s14, 0
  s_mov_b64 exec, vcc
L_rednlS:
  buffer_load_dwordx4 v[20:23], v7, s[72:75], s17 offen offset:0 sc1
  buffer_load_dwordx4 v[24:27], v7, s[72:75], s17 offen offset:2048 sc1
  buffer_load_dwordx4 v[28:31], v7, s[72:75], s18 offen offset:0 sc1
  buffer_load_dwordx4 v[32:35], v7, s[72:75], s18 offen offset:2048 sc1
  s_add_u32 s14, s14, 1
  s_cmp_gt_u32 s14, 200000
  s_cbranch_scc1 L_end
  s_waitcnt vmcnt(12)
  v_bitop3_b32 v44, v20, v22, s21 bitop3:0x7e
  v_bitop3_b32 v45, v24, v26, s21 bitop3:0x7e
  v_bitop3_b32 v46, v28, v30, s21 bitop3:0x7e
  v_or3_b32 v44, v44, v45, v46
  v_and_b32 v44, 1, v44
  v_bitop3_b32 v47, v32, v34, s21 bitop3:0x7e
  v_and_or_b32 v44, v47, 1, v44
  v_cmp_ne_u32 vcc, 0, v44
  s_nop 0
  s_and_b64 exec, exec, vcc
  s_cbranch_scc1 L_rednlS
L_rednxS:
  s_mov_b64 exec, -1
  v_mfma_f32_16x16x32_bf16 v[48:51], v[36:39], v[20:23], 0
  v_mfma_f32_16x16x32_bf16 v[48:51], v[36:39], v[24:27], v[48:51]
  v_mfma_f32_16x16x32_bf16 v[48:51], v[36:39], v[28:31], v[48:51]
  v_mfma_f32_16x16x32_bf16 v[48:51], v[36:39], v[32:35], v[48:51]
  s_nop 4
  s_branch L_redokS
L_pm0S:
  s_mov_b32 s14, 0
  s_mov_b64 exec, vcc
L_pm0lS:
  buffer_load_dwordx4 v[20:23], v1, s[72:75], s20 offen offset:0 sc1
  s_add_u32 s14, s14, 1
  s_cmp_gt_u32 s14, 200000
  s_cbranch_scc1 L_end
  s_waitcnt vmcnt(12)
  v_max3_u32 v28, v20, v21, v22
  v_max_u32 v28, v28, v23
  v_cmp_eq_u32 vcc, -1, v28
  s_nop 0
  s_and_b64 exec, exec, vcc
  s_cbranch_scc1 L_pm0lS
L_pm0xS:
  s_mov_b64 exec, -1
  ds_write_b128 v3, v[20:23] offset:0
  s_cmp_lt_u32 s12, 63
  v_smfmac_f32_16x16x64_bf16 v[52:55], v[20:23], v[84:91], v11
  v_smfmac_f32_16x16x64_bf16 v[56:59], v[20:23], v[92:99], v11
  v_smfmac_f32_16x16x64_bf16 v[60:63], v[20:23], a[128:135], v11
  s_branch L_c1S
L_pm1S:
  s_mov_b32 s14, 0
  s_mov_b64 exec, vcc
L_pm1lS:
  buffer_load_dwordx4 v[24:27], v1, s[72:75], s20 offen offset:1024 sc1
  s_add_u32 s14, s14, 1
  s_cmp_gt_u32 s14, 200000
  s_cbranch_scc1 L_end
  s_waitcnt vmcnt(12)
  v_max3_u32 v28, v24, v25, v26
  v_max_u32 v28, v28, v27
  v_cmp_eq_u32 vcc, -1, v28
  s_nop 0
  s_and_b64 exec, exec, vcc
  s_cbranch_scc1 L_pm1lS
L_pm1xS:
  s_mov_b64 exec, -1
  ds_write_b128 v3, v[24:27] offset:1024
  s_cmp_lt_u32 s12, 63
  s_branch L_c2S
L_kvwS:
  v_and_b32 v41, 16, v1
  v_lshlrev_b32 v41, 3, v41
  s_mov_b32 s14, 0
L_kvp_7:
  buffer_load_dword v40, v41, s[72:75], s13 offen sc1
  s_add_u32 s14, s14, 1
  s_cmp_gt_u32 s14, 200000
  s_cbranch_scc1 L_end
  s_waitcnt vmcnt(0)
L_kvp_7c:
  v_lshlrev_b32 v40, 3, v40
  v_lshrrev_b32 v42, 5, v41
  v_add_u32 v40, v40, v42
  v_cmp_ge_u32 vcc, s76, v40
  s_nop 0
  s_and_b32 s10, vcc_lo, 3
  s_cbranch_scc1 L_kvp_7
  s_branch L_kvrS
L_oxS:
  s_mov_b32 s14, 0
L_oxlS:
  ds_read_b128 v[40:43], v125 offset:16384
  ds_read_b128 v[44:47], v126 offset:16384
  ds_read_b128 v[36:39], v127 offset:16384
  s_add_u32 s14, s14, 1
  s_cmp_gt_u32 s14, 200000
  s_cbranch_scc1 L_end
  s_waitcnt lgkmcnt(0)
  v_max3_u32 v48, v42, v46, v38
  v_cmp_eq_u32 vcc, -1, v48
  s_cbranch_vccnz L_oxlS
  v_mov_b64 v[20:21], 0
  v_mov_b64 v[22:23], 0
  v_mov_b64 v[24:25], 0
  v_mov_b64 v[26:27], 0
  v_mov_b64 v[28:29], 0
  v_mov_b64 v[30:31], 0
  v_mov_b64 v[32:33], 0
  v_mov_b64 v[34:35], 0
  v_smfmac_f32_16x16x64_bf16 v[20:23], v[60:63], v[176:183], v11
  v_smfmac_f32_16x16x64_bf16 v[24:27], v[60:63], v[192:199], v11
  v_smfmac_f32_16x16x64_bf16 v[28:31], v[60:63], v[208:215], v11
  v_smfmac_f32_16x16x64_bf16 v[32:35], v[60:63], v[224:231], v11
  v_smfmac_f32_16x16x64_bf16 v[20:23], v[40:43], v[184:191], v11
  v_smfmac_f32_16x16x64_bf16 v[20:23], v[44:47], v[240:247], v11
  v_smfmac_f32_16x16x64_bf16 v[20:23], v[36:39], v[248:255], v11
  v_smfmac_f32_16x16x64_bf16 v[24:27], v[40:43], v[200:207], v11
  v_smfmac_f32_16x16x64_bf16 v[24:27], v[44:47], v[68:75], v11
  v_cvt_pk_bf16_f32 v20, v20, v22
  v_smfmac_f32_16x16x64_bf16 v[24:27], v[36:39], v[76:83], v11
  s_branch L_oxretS
L_fbS:
  s_waitcnt lgkmcnt(0)
  s_sub_u32 s76, s23, s44
  s_sub_u32 s76, s76, 0x80000
  s_add_u32 s14, s76, 4096
  buffer_load_dwordx4 v[20:23], v1, s[72:75], s76 offen offset:0 sc1
  s_nop 1
  buffer_load_dwordx4 v[24:27], v1, s[72:75], s76 offen offset:1024 sc1
  buffer_load_dwordx4 v[28:31], v1, s[72:75], s76 offen offset:2048 sc1
  buffer_load_dwordx4 v[32:35], v1, s[72:75], s76 offen offset:3072 sc1
  buffer_load_dwordx4 v[36:39], v1, s[72:75], s14 offen offset:0 sc1
  buffer_load_dwordx4 v[40:43], v1, s[72:75], s14 offen offset:1024 sc1
  buffer_load_dwordx4 v[44:47], v1, s[72:75], s14 offen offset:2048 sc1
  buffer_load_dwordx4 v[48:51], v1, s[72:75], s14 offen offset:3072 sc1
  ds_read_b128 v[68:71], v6 offset:26880
  ds_read_b128 v[72:75], v6 offset:26944
  ds_read_b128 v[76:79], v6 offset:27008
  ds_read_b128 v[80:83], v6 offset:27072
  ds_read_b128 v[84:87], v6 offset:24576
  ds_read_b128 v[88:91], v6 offset:24640
  ds_read_b128 v[92:95], v6 offset:24704
  ds_read_b128 v[96:99], v6 offset:24768
  s_waitcnt vmcnt(0) lgkmcnt(0)
  v_mfma_f32_16x16x32_bf16 v[116:119], v[20:23], v[68:71], 0
  v_mfma_f32_16x16x32_bf16 v[116:119], v[24:27], v[72:75], v[116:119]
  v_mfma_f32_16x16x32_bf16 v[116:119], v[28:31], v[76:79], v[116:119]
  v_mfma_f32_16x16x32_bf16 v[116:119], v[32:35], v[80:83], v[116:119]
  v_mfma_f32_16x16x32_bf16 v[120:123], v[36:39], v[68:71], 0
  v_mfma_f32_16x16x32_bf16 v[120:123], v[40:43], v[72:75], v[120:123]
  v_mfma_f32_16x16x32_bf16 v[120:123], v[44:47], v[76:79], v[120:123]
  v_mfma_f32_16x16x32_bf16 v[120:123], v[48:51], v[80:83], v[120:123]
  v_mfma_f32_16x16x32_bf16 v[36:39], v[84:87], v[68:71], 0
  v_mfma_f32_16x16x32_bf16 v[36:39], v[88:91], v[72:75], v[36:39]
  v_mfma_f32_16x16x32_bf16 v[36:39], v[92:95], v[76:79], v[36:39]
  v_mfma_f32_16x16x32_bf16 v[36:39], v[96:99], v[80:83], v[36:39]
  s_nop 7
  v_mul_f32 v36, s28, v36
  v_mul_f32 v37, s28, v37
  v_max3_f32 v40, v116, v117, v118
  v_max3_f32 v40, v40, v119, v120
  v_max3_f32 v40, v40, v121, v122
  v_max3_f32 v40, v40, v123, v36
  v_max_f32 v40, v40, v37
  v_mov_b32 v41, v40
  s_nop 1
  v_permlane16_swap_b32 v40, v41
  v_max_f32 v40, v40, v41
  v_mov_b32 v41, v40
  s_nop 1
  v_permlane32_swap_b32 v40, v41
  v_max_f32 v40, v40, v41
  v_sub_f32 v116, v116, v40
  v_exp_f32 v116, v116
  v_sub_f32 v117, v117, v40
  v_exp_f32 v117, v117
  v_sub_f32 v118, v118, v40
  v_exp_f32 v118, v118
  v_sub_f32 v119, v119, v40
  v_exp_f32 v119, v119
  v_sub_f32 v120, v120, v40
  v_exp_f32 v120, v120
  v_sub_f32 v121, v121, v40
  v_exp_f32 v121, v121
  v_sub_f32 v122, v122, v40
  v_exp_f32 v122, v122
  v_sub_f32 v123, v123, v40
  v_exp_f32 v123, v123
  v_sub_f32 v36, v36, v40
  v_exp_f32 v36, v36
  v_sub_f32 v37, v37, v40
  v_exp_f32 v37, v37
  v_cvt_pk_bf16_f32 v116, v116, v117
  v_cvt_pk_bf16_f32 v117, v118, v119
  v_cvt_pk_bf16_f32 v118, v120, v121
  v_cvt_pk_bf16_f32 v119, v122, v123
  v_cvt_pk_bf16_f32 v14, v36, v37
  v_cvt_pk_bf16_f32 v15, v36, v37
  v_mfma_f32_16x16x32_bf16 v[52:55], v[16:19], v[116:119], 0
  v_mfma_f32_16x16x32_bf16 v[60:63], v[56:59], v[116:119], 0
  v_mfma_f32_16x16x32_bf16 v[64:67], v[108:111], v[116:119], 0
  v_mfma_f32_16x16x16_bf16 v[52:55], v[12:13], v[14:15], v[52:55]
  v_mfma_f32_16x16x16_bf16 v[60:63], v[100:101], v[14:15], v[60:63]
  v_mfma_f32_16x16x16_bf16 v[64:67], v[102:103], v[14:15], v[64:67]
  ds_read_b128 v[68:71], v0 offset:32768
  ds_read_b128 v[72:75], v0 offset:33792
  v_mov_b64 v[20:21], 0
  v_mov_b64 v[22:23], 0
  v_mov_b64 v[24:25], 0
  v_mov_b64 v[26:27], 0
  v_mov_b64 v[28:29], 0
  v_mov_b64 v[30:31], 0
  v_mov_b64 v[32:33], 0
  v_mov_b64 v[34:35], 0
  v_rcp_f32 v55, v54
  s_nop 0
  v_mul_f32 v60, v55, v60
  v_mul_f32 v61, v55, v61
  v_mul_f32 v62, v55, v62
  v_mul_f32 v63, v55, v63
  v_cvt_pk_bf16_f32 v60, v60, v61
  v_cvt_pk_bf16_f32 v61, v62, v63
  v_mul_f32 v64, v55, v64
  v_mul_f32 v65, v55, v65
  v_mul_f32 v66, v55, v66
  v_mul_f32 v67, v55, v67
  v_cvt_pk_bf16_f32 v62, v64, v65
  v_cvt_pk_bf16_f32 v63, v66, v67
  ds_write_b128 v3, v[60:63] offset:16384
  s_waitcnt lgkmcnt(0)
  s_barrier
  ds_read_b128 v[40:43], v125 offset:16384
  ds_read_b128 v[44:47], v126 offset:16384
  ds_read_b128 v[36:39], v127 offset:16384
  v_smfmac_f32_16x16x64_bf16 v[20:23], v[60:63], v[176:183], v11
  v_smfmac_f32_16x16x64_bf16 v[24:27], v[60:63], v[192:199], v11
  s_waitcnt lgkmcnt(0)
  s_branch L_fbretS
L_foll:
  s_sub_u32 s9, s8, 1
  s_lshl_b32 s9, s9, 5
  s_add_u32 s7, s9, s5
  s_mul_i32 s9, s7, 10923
  s_lshr_b32 s9, s9, 16
  s_mul_i32 s6, s9, 6
  s_sub_u32 s6, s7, s6
  s_cmp_eq_u32 s8, 7
  s_cselect_b32 s5, s5, s9
  s_cselect_b32 s6, 6, s6
  s_lshl_b32 s9, s4, 12
  s_lshl_b32 s13, s5, 8
  v_and_b32 v8, 0x70, v0
  v_lshlrev_b32 v8, 1, v8
  v_and_b32 v4, 0xf, v0
  v_lshlrev_b32 v4, 4, v4
  v_xor_b32 v8, v8, v4
  v_and_b32 v4, 0x30, v0
  v_lshlrev_b32 v4, 9, v4
  v_xor_b32 v8, v8, v4
  v_and_b32 v4, 0x40, v0
  v_lshlrev_b32 v4, 10, v4
  v_xor_b32 v8, v8, v4
  v_and_b32 v4, 0x80, v0
  v_lshlrev_b32 v4, 11, v4
  v_xor_b32 v8, v8, v4
  s_cmp_ge_u32 s6, 2
  s_cbranch_scc1 L_roleC
  s_add_u32 m0, s9, 0x0
  s_add_u32 s10, s13, 0x0
  buffer_load_dwordx4 v8, s[44:47], s10 offen lds
  s_add_u32 m0, s9, 0x400
  s_add_u32 s10, s13, 0x8000
  buffer_load_dwordx4 v8, s[44:47], s10 offen lds
  s_add_u32 m0, s9, 0x800
  s_add_u32 s10, s13, 0x20000
  buffer_load_dwordx4 v8, s[44:47], s10 offen lds
  s_add_u32 m0, s9, 0xc00
  s_add_u32 s10, s13, 0x28000
  buffer_load_dwordx4 v8, s[44:47], s10 offen lds
  s_add_u32 m0, s9, 0x4000
  s_add_u32 s10, s13, 0x80000
  buffer_load_dwordx4 v8, s[44:47], s10 offen lds
  s_add_u32 m0, s9, 0x4400
  s_add_u32 s10, s13, 0x88000
  buffer_load_dwordx4 v8, s[44:47], s10 offen lds
  s_add_u32 m0, s9, 0x4800
  s_add_u32 s10, s13, 0xa0000
  buffer_load_dwordx4 v8, s[44:47], s10 offen lds
  s_add_u32 m0, s9, 0x4c00
  s_add_u32 s10, s13, 0xa8000
  buffer_load_dwordx4 v8, s[44:47], s10 offen lds
  s_add_u32 m0, s9, 0x8000
  s_add_u32 s10, s13, 0x100000
  buffer_load_dwordx4 v8, s[44:47], s10 offen lds
  s_add_u32 m0, s9, 0x8400
  s_add_u32 s10, s13, 0x108000
  buffer_load_dwordx4 v8, s[44:47], s10 offen lds
  s_add_u32 m0, s9, 0x8800
  s_add_u32 s10, s13, 0x120000
  buffer_load_dwordx4 v8, s[44:47], s10 offen lds
  s_add_u32 m0, s9, 0x8c00
  s_add_u32 s10, s13, 0x128000
  buffer_load_dwordx4 v8, s[44:47], s10 offen lds
  s_add_u32 m0, s9, 0xc000
  s_add_u32 s10, s13, 0x180000
  buffer_load_dwordx4 v8, s[44:47], s10 offen lds
  s_add_u32 m0, s9, 0xc400
  s_add_u32 s10, s13, 0x188000
  buffer_load_dwordx4 v8, s[44:47], s10 offen lds
  s_add_u32 m0, s9, 0xc800
  s_add_u32 s10, s13, 0x1a0000
  buffer_load_dwordx4 v8, s[44:47], s10 offen lds
  s_add_u32 m0, s9, 0xcc00
  s_add_u32 s10, s13, 0x1a8000
  buffer_load_dwordx4 v8, s[44:47], s10 offen lds
  s_add_u32 m0, s9, 0x10000
  s_add_u32 s10, s13, 0x200000
  buffer_load_dwordx4 v8, s[44:47], s10 offen lds
  s_add_u32 m0, s9, 0x10400
  s_add_u32 s10, s13, 0x208000
  buffer_load_dwordx4 v8, s[44:47], s10 offen lds
  s_add_u32 m0, s9, 0x10800
  s_add_u32 s10, s13, 0x220000
  buffer_load_dwordx4 v8, s[44:47], s10 offen lds
  s_add_u32 m0, s9, 0x10c00
  s_add_u32 s10, s13, 0x228000
  buffer_load_dwordx4 v8, s[44:47], s10 offen lds
  s_add_u32 m0, s9, 0x14000
  s_add_u32 s10, s13, 0x280000
  buffer_load_dwordx4 v8, s[44:47], s10 offen lds
  s_add_u32 m0, s9, 0x14400
  s_add_u32 s10, s13, 0x288000
  buffer_load_dwordx4 v8, s[44:47], s10 offen lds
  s_add_u32 m0, s9, 0x14800
  s_add_u32 s10, s13, 0x2a0000
  buffer_load_dwordx4 v8, s[44:47], s10 offen lds
  s_add_u32 m0, s9, 0x14c00
  s_add_u32 s10, s13, 0x2a8000
  buffer_load_dwordx4 v8, s[44:47], s10 offen lds
  s_add_u32 m0, s9, 0x18000
  s_add_u32 s10, s13, 0x300000
  buffer_load_dwordx4 v8, s[44:47], s10 offen lds
  s_add_u32 m0, s9, 0x18400
  s_add_u32 s10, s13, 0x308000
  buffer_load_dwordx4 v8, s[44:47], s10 offen lds
  s_add_u32 m0, s9, 0x18800
  s_add_u32 s10, s13, 0x320000
  buffer_load_dwordx4 v8, s[44:47], s10 offen lds
  s_add_u32 m0, s9, 0x18c00
  s_add_u32 s10, s13, 0x328000
  buffer_load_dwordx4 v8, s[44:47], s10 offen lds
  s_add_u32 m0, s9, 0x1c000
  s_add_u32 s10, s13, 0x380000
  buffer_load_dwordx4 v8, s[44:47], s10 offen lds
  s_add_u32 m0, s9, 0x1c400
  s_add_u32 s10, s13, 0x388000
  buffer_load_dwordx4 v8, s[44:47], s10 offen lds
  s_add_u32 m0, s9, 0x1c800
  s_add_u32 s10, s13, 0x3a0000
  buffer_load_dwordx4 v8, s[44:47], s10 offen lds
  s_add_u32 m0, s9, 0x1cc00
  s_add_u32 s10, s13, 0x3a8000
  buffer_load_dwordx4 v8, s[44:47], s10 offen lds
  s_add_u32 m0, s9, 0x20000
  s_add_u32 s10, s13, 0x0
  buffer_load_dwordx4 v8, s[48:51], s10 offen lds
  s_add_u32 m0, s9, 0x20400
  s_add_u32 s10, s13, 0x8000
  buffer_load_dwordx4 v8, s[48:51], s10 offen lds
  s_add_u32 m0, s9, 0x20800
  s_add_u32 s10, s13, 0x20000
  buffer_load_dwordx4 v8, s[48:51], s10 offen lds
  s_add_u32 m0, s9, 0x20c00
  s_add_u32 s10, s13, 0x28000
  buffer_load_dwordx4 v8, s[48:51], s10 offen lds
  s_add_u32 m0, s9, 0x24000
  s_add_u32 s10, s13, 0x80000
  buffer_load_dwordx4 v8, s[48:51], s10 offen lds
  s_add_u32 m0, s9, 0x24400
  s_add_u32 s10, s13, 0x88000
  buffer_load_dwordx4 v8, s[48:51], s10 offen lds
  s_add_u32 m0, s9, 0x24800
  s_add_u32 s10, s13, 0xa0000
  buffer_load_dwordx4 v8, s[48:51], s10 offen lds
  s_add_u32 m0, s9, 0x24c00
  s_add_u32 s10, s13, 0xa8000
  buffer_load_dwordx4 v8, s[48:51], s10 offen lds
  v_and_b32 v10, 0xc0, v0
  v_and_b32 v11, 0x1f, v0
  v_lshlrev_b32 v11, 3, v11
  v_xor_b32 v10, v10, v11
  v_and_b32 v11, 0x2c, v0
  v_lshlrev_b32 v11, 6, v11
  v_xor_b32 v10, v10, v11
  v_and_b32 v11, 0x10, v0
  v_lshlrev_b32 v11, 8, v11
  v_xor_b32 v10, v10, v11
  v_xor_b32 v11, 32, v10
  v_add_u32 v12, 0x10000, v10
  v_add_u32 v13, 0x10000, v11
  v_add_u32 v14, 0x20000, v10
  v_add_u32 v15, 0x20000, v11
  s_mov_b32 s12, 32
  s_waitcnt vmcnt(0)
  s_barrier
  ds_read_b64_tr_b16 a[0:1], v10 offset:0
  ds_read_b64_tr_b16 a[2:3], v10 offset:1024
  ds_read_b64_tr_b16 a[4:5], v10 offset:8192
  ds_read_b64_tr_b16 a[6:7], v10 offset:9216
  ds_read_b64_tr_b16 a[8:9], v11 offset:0
  ds_read_b64_tr_b16 a[10:11], v11 offset:1024
  ds_read_b64_tr_b16 a[12:13], v11 offset:8192
  ds_read_b64_tr_b16 a[14:15], v11 offset:9216
  ds_read_b64_tr_b16 a[16:17], v10 offset:16384
  ds_read_b64_tr_b16 a[18:19], v10 offset:17408
  ds_read_b64_tr_b16 a[20:21], v10 offset:24576
  ds_read_b64_tr_b16 a[22:23], v10 offset:25600
  ds_read_b64_tr_b16 a[24:25], v11 offset:16384
  ds_read_b64_tr_b16 a[26:27], v11 offset:17408
  ds_read_b64_tr_b16 a[28:29], v11 offset:24576
  ds_read_b64_tr_b16 a[30:31], v11 offset:25600
  ds_read_b64_tr_b16 a[32:33], v10 offset:32768
  ds_read_b64_tr_b16 a[34:35], v10 offset:33792
  ds_read_b64_tr_b16 a[36:37], v10 offset:40960
  ds_read_b64_tr_b16 a[38:39], v10 offset:41984
  ds_read_b64_tr_b16 a[40:41], v11 offset:32768
  ds_read_b64_tr_b16 a[42:43], v11 offset:33792
  ds_read_b64_tr_b16 a[44:45], v11 offset:40960
  ds_read_b64_tr_b16 a[46:47], v11 offset:41984
  ds_read_b64_tr_b16 a[48:49], v10 offset:49152
  ds_read_b64_tr_b16 a[50:51], v10 offset:50176
  ds_read_b64_tr_b16 a[52:53], v10 offset:57344
  ds_read_b64_tr_b16 a[54:55], v10 offset:58368
  ds_read_b64_tr_b16 a[56:57], v11 offset:49152
  ds_read_b64_tr_b16 a[58:59], v11 offset:50176
  ds_read_b64_tr_b16 a[60:61], v11 offset:57344
  ds_read_b64_tr_b16 a[62:63], v11 offset:58368
  ds_read_b64_tr_b16 a[64:65], v12 offset:0
  ds_read_b64_tr_b16 a[66:67], v12 offset:1024
  ds_read_b64_tr_b16 a[68:69], v12 offset:8192
  ds_read_b64_tr_b16 a[70:71], v12 offset:9216
  ds_read_b64_tr_b16 a[72:73], v13 offset:0
  ds_read_b64_tr_b16 a[74:75], v13 offset:1024
  ds_read_b64_tr_b16 a[76:77], v13 offset:8192
  ds_read_b64_tr_b16 a[78:79], v13 offset:9216
  ds_read_b64_tr_b16 a[80:81], v12 offset:16384
  ds_read_b64_tr_b16 a[82:83], v12 offset:17408
  ds_read_b64_tr_b16 a[84:85], v12 offset:24576
  ds_read_b64_tr_b16 a[86:87], v12 offset:25600
  ds_read_b64_tr_b16 a[88:89], v13 offset:16384
  ds_read_b64_tr_b16 a[90:91], v13 offset:17408
  ds_read_b64_tr_b16 a[92:93], v13 offset:24576
  ds_read_b64_tr_b16 a[94:95], v13 offset:25600
  ds_read_b64_tr_b16 a[96:97], v12 offset:32768
  ds_read_b64_tr_b16 a[98:99], v12 offset:33792
  ds_read_b64_tr_b16 a[100:101], v12 offset:40960
  ds_read_b64_tr_b16 a[102:103], v12 offset:41984
  ds_read_b64_tr_b16 a[104:105], v13 offset:32768
  ds_read_b64_tr_b16 a[106:107], v13 offset:33792
  ds_read_b64_tr_b16 a[108:109], v13 offset:40960
  ds_read_b64_tr_b16 a[110:111], v13 offset:41984
  ds_read_b64_tr_b16 a[112:113], v12 offset:49152
  ds_read_b64_tr_b16 a[114:115], v12 offset:50176
  ds_read_b64_tr_b16 a[116:117], v12 offset:57344
  ds_read_b64_tr_b16 a[118:119], v12 offset:58368
  ds_read_b64_tr_b16 a[120:121], v13 offset:49152
  ds_read_b64_tr_b16 a[122:123], v13 offset:50176
  ds_read_b64_tr_b16 a[124:125], v13 offset:57344
  ds_read_b64_tr_b16 a[126:127], v13 offset:58368
  ds_read_b64_tr_b16 a[128:129], v14 offset:0
  ds_read_b64_tr_b16 a[130:131], v14 offset:1024
  ds_read_b64_tr_b16 a[132:133], v14 offset:8192
  ds_read_b64_tr_b16 a[134:135], v14 offset:9216
  ds_read_b64_tr_b16 a[136:137], v15 offset:0
  ds_read_b64_tr_b16 a[138:139], v15 offset:1024
  ds_read_b64_tr_b16 a[140:141], v15 offset:8192
  ds_read_b64_tr_b16 a[142:143], v15 offset:9216
  ds_read_b64_tr_b16 a[144:145], v14 offset:16384
  ds_read_b64_tr_b16 a[146:147], v14 offset:17408
  ds_read_b64_tr_b16 a[148:149], v14 offset:24576
  ds_read_b64_tr_b16 a[150:151], v14 offset:25600
  ds_read_b64_tr_b16 a[152:153], v15 offset:16384
  ds_read_b64_tr_b16 a[154:155], v15 offset:17408
  ds_read_b64_tr_b16 a[156:157], v15 offset:24576
  ds_read_b64_tr_b16 a[158:159], v15 offset:25600
  s_waitcnt lgkmcnt(0)
  s_barrier
  s_add_u32 m0, s9, 0x10000
  s_add_u32 s10, s13, 0x100000
  buffer_load_dwordx4 v8, s[48:51], s10 offen lds
  s_add_u32 m0, s9, 0x10400
  s_add_u32 s10, s13, 0x108000
  buffer_load_dwordx4 v8, s[48:51], s10 offen lds
  s_add_u32 m0, s9, 0x10800
  s_add_u32 s10, s13, 0x120000
  buffer_load_dwordx4 v8, s[48:51], s10 offen lds
  s_add_u32 m0, s9, 0x10c00
  s_add_u32 s10, s13, 0x128000
  buffer_load_dwordx4 v8, s[48:51], s10 offen lds
  s_add_u32 m0, s9, 0x14000
  s_add_u32 s10, s13, 0x180000
  buffer_load_dwordx4 v8, s[48:51], s10 offen lds
  s_add_u32 m0, s9, 0x14400
  s_add_u32 s10, s13, 0x188000
  buffer_load_dwordx4 v8, s[48:51], s10 offen lds
  s_add_u32 m0, s9, 0x14800
  s_add_u32 s10, s13, 0x1a0000
  buffer_load_dwordx4 v8, s[48:51], s10 offen lds
  s_add_u32 m0, s9, 0x14c00
  s_add_u32 s10, s13, 0x1a8000
  buffer_load_dwordx4 v8, s[48:51], s10 offen lds
  s_add_u32 m0, s9, 0x18000
  s_add_u32 s10, s13, 0x200000
  buffer_load_dwordx4 v8, s[48:51], s10 offen lds
  s_add_u32 m0, s9, 0x18400
  s_add_u32 s10, s13, 0x208000
  buffer_load_dwordx4 v8, s[48:51], s10 offen lds
  s_add_u32 m0, s9, 0x18800
  s_add_u32 s10, s13, 0x220000
  buffer_load_dwordx4 v8, s[48:51], s10 offen lds
  s_add_u32 m0, s9, 0x18c00
  s_add_u32 s10, s13, 0x228000
  buffer_load_dwordx4 v8, s[48:51], s10 offen lds
  s_add_u32 m0, s9, 0x1c000
  s_add_u32 s10, s13, 0x280000
  buffer_load_dwordx4 v8, s[48:51], s10 offen lds
  s_add_u32 m0, s9, 0x1c400
  s_add_u32 s10, s13, 0x288000
  buffer_load_dwordx4 v8, s[48:51], s10 offen lds
  s_add_u32 m0, s9, 0x1c800
  s_add_u32 s10, s13, 0x2a0000
  buffer_load_dwordx4 v8, s[48:51], s10 offen lds
  s_add_u32 m0, s9, 0x1cc00
  s_add_u32 s10, s13, 0x2a8000
  buffer_load_dwordx4 v8, s[48:51], s10 offen lds
  s_add_u32 m0, s9, 0x20000
  s_add_u32 s10, s13, 0x300000
  buffer_load_dwordx4 v8, s[48:51], s10 offen lds
  s_add_u32 m0, s9, 0x20400
  s_add_u32 s10, s13, 0x308000
  buffer_load_dwordx4 v8, s[48:51], s10 offen lds
  s_add_u32 m0, s9, 0x20800
  s_add_u32 s10, s13, 0x320000
  buffer_load_dwordx4 v8, s[48:51], s10 offen lds
  s_add_u32 m0, s9, 0x20c00
  s_add_u32 s10, s13, 0x328000
  buffer_load_dwordx4 v8, s[48:51], s10 offen lds
  s_add_u32 m0, s9, 0x24000
  s_add_u32 s10, s13, 0x380000
  buffer_load_dwordx4 v8, s[48:51], s10 offen lds
  s_add_u32 m0, s9, 0x24400
  s_add_u32 s10, s13, 0x388000
  buffer_load_dwordx4 v8, s[48:51], s10 offen lds
  s_add_u32 m0, s9, 0x24800
  s_add_u32 s10, s13, 0x3a0000
  buffer_load_dwordx4 v8, s[48:51], s10 offen lds
  s_add_u32 m0, s9, 0x24c00
  s_add_u32 s10, s13, 0x3a8000
  buffer_load_dwordx4 v8, s[48:51], s10 offen lds
  s_mov_b32 s14, 0
L_rdy_8:
  buffer_load_dword v4, off, s[68:71], 0 offset:128 sc1
  s_add_u32 s14, s14, 1
  s_cmp_gt_u32 s14, 200000
  s_cbranch_scc1 L_end
  s_waitcnt vmcnt(0)
  v_readfirstlane_b32 s10, v4
  s_nop 0
  s_cmp_eq_u32 s10, 0
  s_cbranch_scc1 L_rdy_8
  s_cmp_lg_u32 s10, s95
  s_cbranch_scc1 L_restart
  v_lshlrev_b32 v3, 3, v2
  s_mov_b32 s14, 0
L_lnp_9:
  buffer_load_dwordx2 v[4:5], v3, s[72:75], 0 offen offset:0 sc1
  s_add_u32 s14, s14, 1
  s_cmp_gt_u32 s14, 200000
  s_cbranch_scc1 L_end
  s_waitcnt vmcnt(0)
  v_and_b32 v4, v4, v5
  v_cmp_ne_u32 vcc, 1, v4
  s_cbranch_vccnz L_lnp_9
  s_lshl_b32 s15, s6, 15
  s_lshl_b32 s10, s4, 13
  s_add_u32 s15, s15, s10
  s_add_u32 s15, s15, 0x100000
  s_lshl_b32 s18, s4, 13
  s_add_u32 m0, s18, 0
  s_add_u32 s10, s15, 0
  buffer_load_dwordx4 v1, s[72:75], s10 offen offset:0 sc1 lds
  buffer_load_dwordx4 v1, s[72:75], s10 offen offset:1024 sc1 lds
  buffer_load_dwordx4 v1, s[72:75], s10 offen offset:2048 sc1 lds
  buffer_load_dwordx4 v1, s[72:75], s10 offen offset:3072 sc1 lds
  s_add_u32 m0, s18, 4096
  s_add_u32 s10, s15, 4096
  buffer_load_dwordx4 v1, s[72:75], s10 offen offset:0 sc1 lds
  buffer_load_dwordx4 v1, s[72:75], s10 offen offset:1024 sc1 lds
  buffer_load_dwordx4 v1, s[72:75], s10 offen offset:2048 sc1 lds
  buffer_load_dwordx4 v1, s[72:75], s10 offen offset:3072 sc1 lds
  s_barrier
  ds_read_b64_tr_b16 a[160:161], v12 offset:0
  ds_read_b64_tr_b16 a[162:163], v12 offset:1024
  ds_read_b64_tr_b16 a[164:165], v12 offset:8192
  ds_read_b64_tr_b16 a[166:167], v12 offset:9216
  ds_read_b64_tr_b16 a[168:169], v13 offset:0
  ds_read_b64_tr_b16 a[170:171], v13 offset:1024
  ds_read_b64_tr_b16 a[172:173], v13 offset:8192
  ds_read_b64_tr_b16 a[174:175], v13 offset:9216
  ds_read_b64_tr_b16 a[176:177], v12 offset:16384
  ds_read_b64_tr_b16 a[178:179], v12 offset:17408
  ds_read_b64_tr_b16 a[180:181], v12 offset:24576
  ds_read_b64_tr_b16 a[182:183], v12 offset:25600
  ds_read_b64_tr_b16 a[184:185], v13 offset:16384
  ds_read_b64_tr_b16 a[186:187], v13 offset:17408
  ds_read_b64_tr_b16 a[188:189], v13 offset:24576
  ds_read_b64_tr_b16 a[190:191], v13 offset:25600
  ds_read_b64_tr_b16 a[192:193], v12 offset:32768
  ds_read_b64_tr_b16 a[194:195], v12 offset:33792
  ds_read_b64_tr_b16 a[196:197], v12 offset:40960
  ds_read_b64_tr_b16 a[198:199], v12 offset:41984
  ds_read_b64_tr_b16 a[200:201], v13 offset:32768
  ds_read_b64_tr_b16 a[202:203], v13 offset:33792
  ds_read_b64_tr_b16 a[204:205], v13 offset:40960
  ds_read_b64_tr_b16 a[206:207], v13 offset:41984
  ds_read_b64_tr_b16 a[208:209], v12 offset:49152
  ds_read_b64_tr_b16 a[210:211], v12 offset:50176
  ds_read_b64_tr_b16 a[212:213], v12 offset:57344
  ds_read_b64_tr_b16 a[214:215], v12 offset:58368
  ds_read_b64_tr_b16 a[216:217], v13 offset:49152
  ds_read_b64_tr_b16 a[218:219], v13 offset:50176
  ds_read_b64_tr_b16 a[220:221], v13 offset:57344
  ds_read_b64_tr_b16 a[222:223], v13 offset:58368
  ds_read_b64_tr_b16 a[224:225], v14 offset:0
  ds_read_b64_tr_b16 a[226:227], v14 offset:1024
  ds_read_b64_tr_b16 a[228:229], v14 offset:8192
  ds_read_b64_tr_b16 a[230:231], v14 offset:9216
  ds_read_b64_tr_b16 a[232:233], v15 offset:0
  ds_read_b64_tr_b16 a[234:235], v15 offset:1024
  ds_read_b64_tr_b16 a[236:237], v15 offset:8192
  ds_read_b64_tr_b16 a[238:239], v15 offset:9216
  ds_read_b64_tr_b16 a[240:241], v14 offset:16384
  ds_read_b64_tr_b16 a[242:243], v14 offset:17408
  ds_read_b64_tr_b16 a[244:245], v14 offset:24576
  ds_read_b64_tr_b16 a[246:247], v14 offset:25600
  ds_read_b64_tr_b16 a[248:249], v15 offset:16384
  ds_read_b64_tr_b16 a[250:251], v15 offset:17408
  ds_read_b64_tr_b16 a[252:253], v15 offset:24576
  ds_read_b64_tr_b16 a[254:255], v15 offset:25600
  s_mov_b32 s19, 0
  s_lshl_b32 s20, s6, 5
  s_add_u32 s20, s20, s5
  s_lshl_b32 s24, s20, 13
  s_lshl_b32 s10, s4, 10
  s_add_u32 s24, s24, s10
  s_add_u32 s24, s24, 0x2440000
  s_lshl_b32 s20, s20, 14
  s_lshl_b32 s10, s4, 10
  s_add_u32 s20, s20, s10
  s_add_u32 s20, s20, 0x400000
  s_add_u32 s21, s20, s10
  s_add_u32 s21, s21, 8192
  s_lshl_b32 s22, s5, 8
  s_lshl_b32 s10, s6, 7
  s_add_u32 s22, s22, s10
  s_add_u32 s22, s22, 0x3000
  s_lshl_b32 s25, s5, 7
  s_add_u32 s25, s25, 0x2000
  v_mov_b32 v9, v1
  s_mov_b32 s23, 0x3e0293ee
  s_mov_b32 s26, s6
  s_lshl_b32 s27, s6, 13
  s_add_u32 s27, s27, 0x300000
  s_lshl_b32 s28, s6, 5
  s_add_u32 s28, s28, s5
  s_lshl_b32 s28, s28, 13
  s_add_u32 s28, s28, 0x2440000
  s_lshl_b32 s10, s4, 10
  s_add_u32 s29, s28, s10
  s_add_u32 s29, s29, 2048
  s_lshl_b32 s10, s4, 6
  s_add_u32 s28, s28, s10
  s_lshl_b32 s30, s6, 4
  s_lshl_b32 s10, s4, 2
  s_add_u32 s30, s30, s10
  s_add_u32 s30, s30, s25
  s_lshl_b32 s31, s4, 13
  s_add_u32 s31, s31, 65536
  s_lshl_b32 s76, s5, 7
  s_add_u32 s76, s76, 0x5000
  s_mov_b32 s77, 0
  v_mov_b32 v100, 0x05040100
  v_mov_b32 v101, 0x07060302
  v_cmp_gt_u32 vcc, 32, v2
  s_nop 1
  v_cndmask_b32 v100, v101, v100, vcc
  v_and_b32 v101, 2, v2
  v_cmp_eq_u32 vcc, 0, v101
  v_mov_b32 v101, 0x0c0c0c0c
  s_nop 0
  v_cndmask_b32 v100, v101, v100, vcc
  v_and_b32 v98, 0xf, v2
  v_lshlrev_b32 v98, 2, v98
  v_and_b32 v101, 0x30, v2
  v_lshlrev_b32 v101, 5, v101
  v_xor_b32 v98, v98, v101
  v_and_b32 v99, 0xd, v2
  v_lshlrev_b32 v99, 4, v99
  v_and_b32 v101, 0x10, v2
  v_lshlrev_b32 v101, 5, v101
  v_xor_b32 v99, v99, v101
  v_add_u32 v99, s31, v99
  v_mov_b32 v96, 0
  s_mov_b32 s16, s26
  s_waitcnt vmcnt(0) lgkmcnt(0)
L_A:
  s_barrier
  s_cmp_lt_u32 s19, 2
  s_cbranch_scc1 L_A_nf
  s_sub_u32 s10, s19, 1
  v_mov_b32 v4, s10
  s_cmp_eq_u32 s4, 0
  s_cselect_b64 exec, 1, 0
  buffer_store_dword v4, off, s[72:75], s22 sc1
  s_mov_b64 exec, -1
L_A_nf:
  s_add_u32 s19, s19, 1
  s_cmp_ge_u32 s19, s12
  s_cbranch_scc1 L_A_nd
  s_add_u32 s15, s15, 65536
  s_xor_b32 s18, s18, 32768
  s_add_u32 m0, s18, 0
  s_add_u32 s10, s15, 0
  buffer_load_dwordx4 v1, s[72:75], s10 offen offset:0 sc1 lds
  buffer_load_dwordx4 v1, s[72:75], s10 offen offset:1024 sc1 lds
  buffer_load_dwordx4 v1, s[72:75], s10 offen offset:2048 sc1 lds
  buffer_load_dwordx4 v1, s[72:75], s10 offen offset:3072 sc1 lds
  s_add_u32 m0, s18, 4096
  s_add_u32 s10, s15, 4096
  buffer_load_dwordx4 v1, s[72:75], s10 offen offset:0 sc1 lds
  buffer_load_dwordx4 v1, s[72:75], s10 offen offset:1024 sc1 lds
  buffer_load_dwordx4 v1, s[72:75], s10 offen offset:2048 sc1 lds
  buffer_load_dwordx4 v1, s[72:75], s10 offen offset:3072 sc1 lds
L_A_nd:
  v_readfirstlane_b32 s17, v96
  s_nop 0
  s_min_u32 s17, s17, 62
  s_cmp_ge_u32 s26, s17
  s_cbranch_scc1 L_A_nm
  s_add_u32 m0, s31, 0
  s_add_u32 s10, s27, 0
  buffer_load_dwordx4 v1, s[72:75], s10 offen offset:0 sc1 lds
  buffer_load_dwordx4 v1, s[72:75], s10 offen offset:1024 sc1 lds
  buffer_load_dwordx4 v1, s[72:75], s10 offen offset:2048 sc1 lds
  buffer_load_dwordx4 v1, s[72:75], s10 offen offset:3072 sc1 lds
  s_add_u32 m0, s31, 4096
  s_add_u32 s10, s27, 4096
  buffer_load_dwordx4 v1, s[72:75], s10 offen offset:0 sc1 lds
  buffer_load_dwordx4 v1, s[72:75], s10 offen offset:1024 sc1 lds
  buffer_load_dwordx4 v1, s[72:75], s10 offen offset:2048 sc1 lds
  buffer_load_dwordx4 v1, s[72:75], s10 offen offset:3072 sc1 lds
L_A_nm:
  s_cmp_lg_u32 s19, 9
  s_cbranch_scc1 L_A_np
  s_add_u32 s10, s6, 32
  s_lshl_b32 s11, s10, 5
  s_add_u32 s11, s11, s5
  s_lshl_b32 s10, s11, 13
  s_add_u32 s10, s10, 0x2440000
  s_lshl_b32 s11, s11, 8
  s_add_u32 s11, s11, 0x300000
  v_mov_b64 v[80:81], -1
  v_mov_b64 v[82:83], -1
  v_and_b32 v97, 0xf, v0
  v_lshlrev_b32 v97, 4, v97
  v_and_b32 v4, 0xf0, v0
  v_lshlrev_b32 v4, 10, v4
  v_xor_b32 v97, v97, v4
  buffer_store_dwordx4 v[80:83], v97, s[72:75], s11 offen sc1
  v_lshlrev_b32 v97, 4, v0
  v_lshlrev_b32 v4, 3, v0
  buffer_store_dwordx4 v[80:83], v97, s[72:75], s10 offen sc1
  s_add_u32 s10, s10, 4096
  buffer_store_dwordx2 v[80:81], v4, s[72:75], s10 offen sc1
  s_add_u32 s10, s10, 520192
  buffer_store_dwordx4 v[80:83], v97, s[72:75], s10 offen sc1
  s_add_u32 s10, s10, 4096
  buffer_store_dwordx2 v[80:81], v4, s[72:75], s10 offen sc1
  s_add_u32 s10, s10, 520192
  buffer_store_dwordx4 v[80:83], v97, s[72:75], s10 offen sc1
  s_add_u32 s10, s10, 4096
  buffer_store_dwordx2 v[80:81], v4, s[72:75], s10 offen sc1
  s_add_u32 s10, s10, 520192
  buffer_store_dwordx4 v[80:83], v97, s[72:75], s10 offen sc1
  s_add_u32 s10, s10, 4096
  buffer_store_dwordx2 v[80:81], v4, s[72:75], s10 offen sc1
  s_add_u32 s10, s10, 520192
  buffer_store_dwordx4 v[80:83], v97, s[72:75], s10 offen sc1
  s_add_u32 s10, s10, 4096
  buffer_store_dwordx2 v[80:81], v4, s[72:75], s10 offen sc1
  s_add_u32 s10, s10, 520192
  buffer_store_dwordx4 v[80:83], v97, s[72:75], s10 offen sc1
  s_add_u32 s10, s10, 4096
  buffer_store_dwordx2 v[80:81], v4, s[72:75], s10 offen sc1
  s_add_u32 s10, s10, 520192
  buffer_store_dwordx4 v[80:83], v97, s[72:75], s10 offen sc1
  s_add_u32 s10, s10, 4096
  buffer_store_dwordx2 v[80:81], v4, s[72:75], s10 offen sc1
  s_add_u32 s10, s10, 520192
  buffer_store_dwordx4 v[80:83], v97, s[72:75], s10 offen sc1
  s_add_u32 s10, s10, 4096
  buffer_store_dwordx2 v[80:81], v4, s[72:75], s10 offen sc1
  s_add_u32 s10, s10, 520192
  buffer_store_dwordx4 v[80:83], v97, s[72:75], s10 offen sc1
  s_add_u32 s10, s10, 4096
  buffer_store_dwordx2 v[80:81], v4, s[72:75], s10 offen sc1
  s_add_u32 s10, s10, 520192
  buffer_store_dwordx4 v[80:83], v97, s[72:75], s10 offen sc1
  s_add_u32 s10, s10, 4096
  buffer_store_dwordx2 v[80:81], v4, s[72:75], s10 offen sc1
  s_add_u32 s10, s10, 520192
  buffer_store_dwordx4 v[80:83], v97, s[72:75], s10 offen sc1
  s_add_u32 s10, s10, 4096
  buffer_store_dwordx2 v[80:81], v4, s[72:75], s10 offen sc1
  s_add_u32 s10, s10, 520192
  buffer_store_dwordx4 v[80:83], v97, s[72:75], s10 offen sc1
  s_add_u32 s10, s10, 4096
  buffer_store_dwordx2 v[80:81], v4, s[72:75], s10 offen sc1
  s_add_u32 s10, s10, 520192
  buffer_store_dwordx4 v[80:83], v97, s[72:75], s10 offen sc1
  s_add_u32 s10, s10, 4096
  buffer_store_dwordx2 v[80:81], v4, s[72:75], s10 offen sc1
  s_add_u32 s10, s10, 520192
  buffer_store_dwordx4 v[80:83], v97, s[72:75], s10 offen sc1
  s_add_u32 s10, s10, 4096
  buffer_store_dwordx2 v[80:81], v4, s[72:75], s10 offen sc1
  s_add_u32 s10, s10, 520192
  buffer_store_dwordx4 v[80:83], v97, s[72:75], s10 offen sc1
  s_add_u32 s10, s10, 4096
  buffer_store_dwordx2 v[80:81], v4, s[72:75], s10 offen sc1
  s_add_u32 s10, s10, 520192
  buffer_store_dwordx4 v[80:83], v97, s[72:75], s10 offen sc1
  s_add_u32 s10, s10, 4096
  buffer_store_dwordx2 v[80:81], v4, s[72:75], s10 offen sc1
  s_add_u32 s10, s10, 520192
L_A_np:
  ds_read_b128 v[16:19], v9 offset:0
  ds_read_b128 v[20:23], v9 offset:16384
  ds_read_b128 v[24:27], v9 offset:1024
  ds_read_b128 v[28:31], v9 offset:17408
  ds_read_b128 v[32:35], v9 offset:2048
  ds_read_b128 v[36:39], v9 offset:18432
  ds_read_b128 v[40:43], v9 offset:3072
  ds_read_b128 v[44:47], v9 offset:19456
  s_waitcnt lgkmcnt(6)
  v_mfma_f32_16x16x32_bf16 v[48:51], a[0:3], v[16:19], 0
  v_mfma_f32_16x16x32_bf16 v[64:67], v[16:19], a[128:131], 0
  v_mfma_f32_16x16x32_bf16 v[52:55], a[8:11], v[16:19], 0
  v_mfma_f32_16x16x32_bf16 v[72:75], v[16:19], a[136:139], 0
  v_mfma_f32_16x16x32_bf16 v[56:59], a[0:3], v[20:23], 0
  v_mfma_f32_16x16x32_bf16 v[68:71], v[20:23], a[128:131], 0
  v_mfma_f32_16x16x32_bf16 v[60:63], a[8:11], v[20:23], 0
  v_mfma_f32_16x16x32_bf16 v[76:79], v[20:23], a[136:139], 0
  ds_read_b128 v[16:19], v9 offset:4096
  ds_read_b128 v[20:23], v9 offset:20480
  s_waitcnt lgkmcnt(6)
  v_mfma_f32_16x16x32_bf16 v[48:51], a[4:7], v[24:27], v[48:51]
  v_mfma_f32_16x16x32_bf16 v[64:67], v[24:27], a[132:135], v[64:67]
  v_mfma_f32_16x16x32_bf16 v[52:55], a[12:15], v[24:27], v[52:55]
  v_mfma_f32_16x16x32_bf16 v[72:75], v[24:27], a[140:143], v[72:75]
  v_mfma_f32_16x16x32_bf16 v[56:59], a[4:7], v[28:31], v[56:59]
  v_mfma_f32_16x16x32_bf16 v[68:71], v[28:31], a[132:135], v[68:71]
  v_mfma_f32_16x16x32_bf16 v[60:63], a[12:15], v[28:31], v[60:63]
  v_mfma_f32_16x16x32_bf16 v[76:79], v[28:31], a[140:143], v[76:79]
  ds_read_b128 v[24:27], v9 offset:5120
  ds_read_b128 v[28:31], v9 offset:21504
  s_waitcnt lgkmcnt(6)
  v_mfma_f32_16x16x32_bf16 v[48:51], a[16:19], v[32:35], v[48:51]
  v_mfma_f32_16x16x32_bf16 v[64:67], v[32:35], a[144:147], v[64:67]
  v_mfma_f32_16x16x32_bf16 v[52:55], a[24:27], v[32:35], v[52:55]
  v_mfma_f32_16x16x32_bf16 v[72:75], v[32:35], a[152:155], v[72:75]
  v_mfma_f32_16x16x32_bf16 v[56:59], a[16:19], v[36:39], v[56:59]
  v_mfma_f32_16x16x32_bf16 v[68:71], v[36:39], a[144:147], v[68:71]
  v_mfma_f32_16x16x32_bf16 v[60:63], a[24:27], v[36:39], v[60:63]
  v_mfma_f32_16x16x32_bf16 v[76:79], v[36:39], a[152:155], v[76:79]
  ds_read_b128 v[32:35], v9 offset:6144
  ds_read_b128 v[36:39], v9 offset:22528
  s_waitcnt lgkmcnt(6)
  v_mfma_f32_16x16x32_bf16 v[48:51], a[20:23], v[40:43], v[48:51]
  v_mfma_f32_16x16x32_bf16 v[64:67], v[40:43], a[148:151], v[64:67]
  v_mfma_f32_16x16x32_bf16 v[52:55], a[28:31], v[40:43], v[52:55]
  v_mfma_f32_16x16x32_bf16 v[72:75], v[40:43], a[156:159], v[72:75]
  v_mfma_f32_16x16x32_bf16 v[56:59], a[20:23], v[44:47], v[56:59]
  v_mfma_f32_16x16x32_bf16 v[68:71], v[44:47], a[148:151], v[68:71]
  v_mfma_f32_16x16x32_bf16 v[60:63], a[28:31], v[44:47], v[60:63]
  v_mfma_f32_16x16x32_bf16 v[76:79], v[44:47], a[156:159], v[76:79]
  ds_read_b128 v[40:43], v9 offset:7168
  ds_read_b128 v[44:47], v9 offset:23552
  s_waitcnt lgkmcnt(6)
  v_mfma_f32_16x16x32_bf16 v[48:51], a[32:35], v[16:19], v[48:51]
  v_mfma_f32_16x16x32_bf16 v[64:67], v[16:19], a[160:163], v[64:67]
  v_mfma_f32_16x16x32_bf16 v[52:55], a[40:43], v[16:19], v[52:55]
  v_mfma_f32_16x16x32_bf16 v[72:75], v[16:19], a[168:171], v[72:75]
  v_mfma_f32_16x16x32_bf16 v[56:59], a[32:35], v[20:23], v[56:59]
  v_mfma_f32_16x16x32_bf16 v[68:71], v[20:23], a[160:163], v[68:71]
  v_mfma_f32_16x16x32_bf16 v[60:63], a[40:43], v[20:23], v[60:63]
  v_mfma_f32_16x16x32_bf16 v[76:79], v[20:23], a[168:171], v[76:79]
  ds_read_b128 v[16:19], v9 offset:8192
  ds_read_b128 v[20:23], v9 offset:24576
  s_waitcnt lgkmcnt(6)
  v_mfma_f32_16x16x32_bf16 v[48:51], a[36:39], v[24:27], v[48:51]
  v_mfma_f32_16x16x32_bf16 v[64:67], v[24:27], a[164:167], v[64:67]
  v_mfma_f32_16x16x32_bf16 v[52:55], a[44:47], v[24:27], v[52:55]
  v_mfma_f32_16x16x32_bf16 v[72:75], v[24:27], a[172:175], v[72:75]
  v_mfma_f32_16x16x32_bf16 v[56:59], a[36:39], v[28:31], v[56:59]
  v_mfma_f32_16x16x32_bf16 v[68:71], v[28:31], a[164:167], v[68:71]
  v_mfma_f32_16x16x32_bf16 v[60:63], a[44:47], v[28:31], v[60:63]
  v_mfma_f32_16x16x32_bf16 v[76:79], v[28:31], a[172:175], v[76:79]
  ds_read_b128 v[24:27], v9 offset:9216
  ds_read_b128 v[28:31], v9 offset:25600
  s_waitcnt lgkmcnt(6)
  v_mfma_f32_16x16x32_bf16 v[48:51], a[48:51], v[32:35], v[48:51]
  v_mfma_f32_16x16x32_bf16 v[64:67], v[32:35], a[176:179], v[64:67]
  v_mfma_f32_16x16x32_bf16 v[52:55], a[56:59], v[32:35], v[52:55]
  v_mfma_f32_16x16x32_bf16 v[72:75], v[32:35], a[184:187], v[72:75]
  v_mfma_f32_16x16x32_bf16 v[56:59], a[48:51], v[36:39], v[56:59]
  v_mfma_f32_16x16x32_bf16 v[68:71], v[36:39], a[176:179], v[68:71]
  v_mfma_f32_16x16x32_bf16 v[60:63], a[56:59], v[36:39], v[60:63]
  v_mfma_f32_16x16x32_bf16 v[76:79], v[36:39], a[184:187], v[76:79]
  ds_read_b128 v[32:35], v9 offset:10240
  ds_read_b128 v[36:39], v9 offset:26624
  s_waitcnt lgkmcnt(6)
  v_mfma_f32_16x16x32_bf16 v[48:51], a[52:55], v[40:43], v[48:51]
  v_mfma_f32_16x16x32_bf16 v[64:67], v[40:43], a[180:183], v[64:67]
  v_mfma_f32_16x16x32_bf16 v[52:55], a[60:63], v[40:43], v[52:55]
  v_mfma_f32_16x16x32_bf16 v[72:75], v[40:43], a[188:191], v[72:75]
  v_mfma_f32_16x16x32_bf16 v[56:59], a[52:55], v[44:47], v[56:59]
  v_mfma_f32_16x16x32_bf16 v[68:71], v[44:47], a[180:183], v[68:71]
  v_mfma_f32_16x16x32_bf16 v[60:63], a[60:63], v[44:47], v[60:63]
  v_mfma_f32_16x16x32_bf16 v[76:79], v[44:47], a[188:191], v[76:79]
  ds_read_b128 v[40:43], v9 offset:11264
  ds_read_b128 v[44:47], v9 offset:27648
  s_waitcnt lgkmcnt(6)
  v_mfma_f32_16x16x32_bf16 v[48:51], a[64:67], v[16:19], v[48:51]
  v_mfma_f32_16x16x32_bf16 v[64:67], v[16:19], a[192:195], v[64:67]
  v_mfma_f32_16x16x32_bf16 v[52:55], a[72:75], v[16:19], v[52:55]
  v_mfma_f32_16x16x32_bf16 v[72:75], v[16:19], a[200:203], v[72:75]
  v_mfma_f32_16x16x32_bf16 v[56:59], a[64:67], v[20:23], v[56:59]
  v_mfma_f32_16x16x32_bf16 v[68:71], v[20:23], a[192:195], v[68:71]
  v_mfma_f32_16x16x32_bf16 v[60:63], a[72:75], v[20:23], v[60:63]
  v_mfma_f32_16x16x32_bf16 v[76:79], v[20:23], a[200:203], v[76:79]
  ds_read_b128 v[16:19], v9 offset:12288
  ds_read_b128 v[20:23], v9 offset:28672
  s_waitcnt lgkmcnt(6)
  v_mfma_f32_16x16x32_bf16 v[48:51], a[68:71], v[24:27], v[48:51]
  v_mfma_f32_16x16x32_bf16 v[64:67], v[24:27], a[196:199], v[64:67]
  v_mfma_f32_16x16x32_bf16 v[52:55], a[76:79], v[24:27], v[52:55]
  v_mfma_f32_16x16x32_bf16 v[72:75], v[24:27], a[204:207], v[72:75]
  v_mfma_f32_16x16x32_bf16 v[56:59], a[68:71], v[28:31], v[56:59]
  v_mfma_f32_16x16x32_bf16 v[68:71], v[28:31], a[196:199], v[68:71]
  v_mfma_f32_16x16x32_bf16 v[60:63], a[76:79], v[28:31], v[60:63]
  v_mfma_f32_16x16x32_bf16 v[76:79], v[28:31], a[204:207], v[76:79]
  ds_read_b128 v[24:27], v9 offset:13312
  ds_read_b128 v[28:31], v9 offset:29696
  s_waitcnt lgkmcnt(6)
  v_mfma_f32_16x16x32_bf16 v[48:51], a[80:83], v[32:35], v[48:51]
  v_mfma_f32_16x16x32_bf16 v[64:67], v[32:35], a[208:211], v[64:67]
  v_mfma_f32_16x16x32_bf16 v[52:55], a[88:91], v[32:35], v[52:55]
  v_mfma_f32_16x16x32_bf16 v[72:75], v[32:35], a[216:219], v[72:75]
  v_mfma_f32_16x16x32_bf16 v[56:59], a[80:83], v[36:39], v[56:59]
  v_mfma_f32_16x16x32_bf16 v[68:71], v[36:39], a[208:211], v[68:71]
  v_mfma_f32_16x16x32_bf16 v[60:63], a[88:91], v[36:39], v[60:63]
  v_mfma_f32_16x16x32_bf16 v[76:79], v[36:39], a[216:219], v[76:79]
  ds_read_b128 v[32:35], v9 offset:14336
  ds_read_b128 v[36:39], v9 offset:30720
  s_waitcnt lgkmcnt(6)
  v_mfma_f32_16x16x32_bf16 v[48:51], a[84:87], v[40:43], v[48:51]
  v_mfma_f32_16x16x32_bf16 v[64:67], v[40:43], a[212:215], v[64:67]
  v_mfma_f32_16x16x32_bf16 v[52:55], a[92:95], v[40:43], v[52:55]
  v_mfma_f32_16x16x32_bf16 v[72:75], v[40:43], a[220:223], v[72:75]
  v_mfma_f32_16x16x32_bf16 v[56:59], a[84:87], v[44:47], v[56:59]
  v_mfma_f32_16x16x32_bf16 v[68:71], v[44:47], a[212:215], v[68:71]
  v_mfma_f32_16x16x32_bf16 v[60:63], a[92:95], v[44:47], v[60:63]
  v_mfma_f32_16x16x32_bf16 v[76:79], v[44:47], a[220:223], v[76:79]
  ds_read_b128 v[40:43], v9 offset:15360
  ds_read_b128 v[44:47], v9 offset:31744
  buffer_load_dword v96, off, s[72:75], s76 sc1
  s_waitcnt lgkmcnt(6)
  v_mfma_f32_16x16x32_bf16 v[48:51], a[96:99], v[16:19], v[48:51]
  v_mfma_f32_16x16x32_bf16 v[64:67], v[16:19], a[224:227], v[64:67]
  v_mfma_f32_16x16x32_bf16 v[52:55], a[104:107], v[16:19], v[52:55]
  v_mfma_f32_16x16x32_bf16 v[72:75], v[16:19], a[232:235], v[72:75]
  v_mfma_f32_16x16x32_bf16 v[56:59], a[96:99], v[20:23], v[56:59]
  v_mfma_f32_16x16x32_bf16 v[68:71], v[20:23], a[224:227], v[68:71]
  v_mfma_f32_16x16x32_bf16 v[60:63], a[104:107], v[20:23], v[60:63]
  v_mfma_f32_16x16x32_bf16 v[76:79], v[20:23], a[232:235], v[76:79]
  s_waitcnt lgkmcnt(4)
  v_mfma_f32_16x16x32_bf16 v[48:51], a[100:103], v[24:27], v[48:51]
  v_mfma_f32_16x16x32_bf16 v[64:67], v[24:27], a[228:231], v[64:67]
  v_mfma_f32_16x16x32_bf16 v[52:55], a[108:111], v[24:27], v[52:55]
  v_mfma_f32_16x16x32_bf16 v[72:75], v[24:27], a[236:239], v[72:75]
  v_mfma_f32_16x16x32_bf16 v[56:59], a[100:103], v[28:31], v[56:59]
  v_mfma_f32_16x16x32_bf16 v[68:71], v[28:31], a[228:231], v[68:71]
  v_mfma_f32_16x16x32_bf16 v[60:63], a[108:111], v[28:31], v[60:63]
  v_mfma_f32_16x16x32_bf16 v[76:79], v[28:31], a[236:239], v[76:79]
  s_waitcnt lgkmcnt(2)
  v_mfma_f32_16x16x32_bf16 v[48:51], a[112:115], v[32:35], v[48:51]
  v_mfma_f32_16x16x32_bf16 v[64:67], v[32:35], a[240:243], v[64:67]
  v_mfma_f32_16x16x32_bf16 v[52:55], a[120:123], v[32:35], v[52:55]
  v_mfma_f32_16x16x32_bf16 v[72:75], v[32:35], a[248:251], v[72:75]
  v_mfma_f32_16x16x32_bf16 v[56:59], a[112:115], v[36:39], v[56:59]
  v_mfma_f32_16x16x32_bf16 v[68:71], v[36:39], a[240:243], v[68:71]
  v_mfma_f32_16x16x32_bf16 v[60:63], a[120:123], v[36:39], v[60:63]
  v_mfma_f32_16x16x32_bf16 v[76:79], v[36:39], a[248:251], v[76:79]
  s_waitcnt lgkmcnt(0)
  v_mfma_f32_16x16x32_bf16 v[48:51], a[116:119], v[40:43], v[48:51]
  v_mfma_f32_16x16x32_bf16 v[64:67], v[40:43], a[244:247], v[64:67]
  v_mfma_f32_16x16x32_bf16 v[52:55], a[124:127], v[40:43], v[52:55]
  v_mfma_f32_16x16x32_bf16 v[72:75], v[40:43], a[252:255], v[72:75]
  v_mfma_f32_16x16x32_bf16 v[56:59], a[116:119], v[44:47], v[56:59]
  v_mfma_f32_16x16x32_bf16 v[68:71], v[44:47], a[244:247], v[68:71]
  v_mfma_f32_16x16x32_bf16 v[60:63], a[124:127], v[44:47], v[60:63]
  v_mfma_f32_16x16x32_bf16 v[76:79], v[44:47], a[252:255], v[76:79]
  v_xor_b32 v9, 32768, v9
  v_mul_f32 v48, s23, v48
  v_mul_f32 v49, s23, v49
  v_mul_f32 v50, s23, v50
  v_mul_f32 v51, s23, v51
  v_mul_f32 v52, s23, v52
  v_mul_f32 v53, s23, v53
  v_mul_f32 v54, s23, v54
  v_mul_f32 v55, s23, v55
  v_cvt_pk_bf16_f32 v80, v48, v52
  v_cvt_pk_bf16_f32 v81, v49, v53
  v_cvt_pk_bf16_f32 v82, v50, v54
  v_cvt_pk_bf16_f32 v83, v51, v55
  buffer_store_dwordx4 v[80:83], v1, s[72:75], s20 offen sc1
  s_add_u32 s10, s20, 4096
  v_mul_f32 v56, s23, v56
  v_mul_f32 v57, s23, v57
  v_mul_f32 v58, s23, v58
  v_mul_f32 v59, s23, v59
  v_mul_f32 v60, s23, v60
  v_mul_f32 v61, s23, v61
  v_mul_f32 v62, s23, v62
  v_mul_f32 v63, s23, v63
  v_cvt_pk_bf16_f32 v84, v56, v60
  v_cvt_pk_bf16_f32 v85, v57, v61
  v_cvt_pk_bf16_f32 v86, v58, v62
  v_cvt_pk_bf16_f32 v87, v59, v63
  buffer_store_dwordx4 v[84:87], v1, s[72:75], s10 offen sc1
  v_cvt_pk_bf16_f32 v88, v64, v65
  v_cvt_pk_bf16_f32 v89, v66, v67
  v_cvt_pk_bf16_f32 v90, v68, v69
  v_cvt_pk_bf16_f32 v91, v70, v71
  buffer_store_dwordx4 v[88:91], v1, s[72:75], s21 offen sc1
  v_cvt_pk_bf16_f32 v92, v72, v73
  v_cvt_pk_bf16_f32 v93, v74, v75
  v_cvt_pk_bf16_f32 v94, v76, v77
  v_cvt_pk_bf16_f32 v95, v78, v79
  buffer_store_dwordx4 v[92:95], v1, s[72:75], s21 offen offset:1024 sc1
  s_add_u32 s20, s20, 1048576
  s_add_u32 s21, s21, 1048576
  s_waitcnt vmcnt(4)
  s_cmp_eq_u32 s16, s26
  s_cbranch_scc1 L_A_na
  s_mov_b32 s16, s26
  s_lshr_b32 s10, s26, 1
  v_mov_b32 v4, s10
  s_mov_b64 exec, 1
  buffer_store_dword v4, off, s[72:75], s30 sc1
  s_mov_b64 exec, -1
L_A_na:
  s_cmp_ge_u32 s26, s17
  s_cbranch_scc1 L_Anext
  ds_read_b128 v[104:107], v99 offset:0
  ds_read_b128 v[108:111], v99 offset:256
  ds_read_b128 v[112:115], v99 offset:32
  ds_read_b128 v[116:119], v99 offset:288
  ds_read_b128 v[120:123], v99 offset:1024
  ds_read_b128 v[124:127], v99 offset:1280
  s_waitcnt lgkmcnt(4)
  v_perm_b32 v136, v105, v104, v100
  v_perm_b32 v137, v107, v106, v100
  v_perm_b32 v138, v109, v108, v100
  v_perm_b32 v139, v111, v110, v100
  ds_read_b128 v[128:131], v99 offset:1056
  ds_read_b128 v[132:135], v99 offset:1312
  v_mfma_f32_16x16x32_bf16 v[48:51], v[136:139], a[0:3], 0
  v_mfma_f32_16x16x32_bf16 v[56:59], v[136:139], a[128:131], 0
  s_waitcnt lgkmcnt(4)
  v_perm_b32 v140, v113, v112, v100
  v_perm_b32 v141, v115, v114, v100
  v_perm_b32 v142, v117, v116, v100
  v_perm_b32 v143, v119, v118, v100
  v_mfma_f32_16x16x32_bf16 v[52:55], v[136:139], a[8:11], 0
  v_mfma_f32_16x16x32_bf16 v[60:63], v[136:139], a[136:139], 0
  ds_read_b128 v[104:107], v99 offset:2048
  ds_read_b128 v[108:111], v99 offset:2304
  v_mfma_f32_16x16x32_bf16 v[48:51], v[140:143], a[4:7], v[48:51]
  v_mfma_f32_16x16x32_bf16 v[56:59], v[140:143], a[132:135], v[56:59]
  s_waitcnt lgkmcnt(4)
  v_perm_b32 v136, v121, v120, v100
  v_perm_b32 v137, v123, v122, v100
  v_perm_b32 v138, v125, v124, v100
  v_perm_b32 v139, v127, v126, v100
  v_mfma_f32_16x16x32_bf16 v[52:55], v[140:143], a[12:15], v[52:55]
  v_mfma_f32_16x16x32_bf16 v[60:63], v[140:143], a[140:143], v[60:63]
  ds_read_b128 v[112:115], v99 offset:2080
  ds_read_b128 v[116:119], v99 offset:2336
  v_mfma_f32_16x16x32_bf16 v[48:51], v[136:139], a[16:19], v[48:51]
  v_mfma_f32_16x16x32_bf16 v[56:59], v[136:139], a[144:147], v[56:59]
  s_waitcnt lgkmcnt(4)
  v_perm_b32 v140, v129, v128, v100
  v_perm_b32 v141, v131, v130, v100
  v_perm_b32 v142, v133, v132, v100
  v_perm_b32 v143, v135, v134, v100
  v_mfma_f32_16x16x32_bf16 v[52:55], v[136:139], a[24:27], v[52:55]
  v_mfma_f32_16x16x32_bf16 v[60:63], v[136:139], a[152:155], v[60:63]
  ds_read_b128 v[120:123], v99 offset:3072
  ds_read_b128 v[124:127], v99 offset:3328
  v_mfma_f32_16x16x32_bf16 v[48:51], v[140:143], a[20:23], v[48:51]
  v_mfma_f32_16x16x32_bf16 v[56:59], v[140:143], a[148:151], v[56:59]
  s_waitcnt lgkmcnt(4)
  v_perm_b32 v136, v105, v104, v100
  v_perm_b32 v137, v107, v106, v100
  v_perm_b32 v138, v109, v108, v100
  v_perm_b32 v139, v111, v110, v100
  v_mfma_f32_16x16x32_bf16 v[52:55], v[140:143], a[28:31], v[52:55]
  v_mfma_f32_16x16x32_bf16 v[60:63], v[140:143], a[156:159], v[60:63]
  ds_read_b128 v[128:131], v99 offset:3104
  ds_read_b128 v[132:135], v99 offset:3360
  v_mfma_f32_16x16x32_bf16 v[48:51], v[136:139], a[32:35], v[48:51]
  v_mfma_f32_16x16x32_bf16 v[56:59], v[136:139], a[160:163], v[56:59]
  s_waitcnt lgkmcnt(4)
  v_perm_b32 v140, v113, v112, v100
  v_perm_b32 v141, v115, v114, v100
  v_perm_b32 v142, v117, v116, v100
  v_perm_b32 v143, v119, v118, v100
  v_mfma_f32_16x16x32_bf16 v[52:55], v[136:139], a[40:43], v[52:55]
  v_mfma_f32_16x16x32_bf16 v[60:63], v[136:139], a[168:171], v[60:63]
  ds_read_b128 v[104:107], v99 offset:4096
  ds_read_b128 v[108:111], v99 offset:4352
  v_mfma_f32_16x16x32_bf16 v[48:51], v[140:143], a[36:39], v[48:51]
  v_mfma_f32_16x16x32_bf16 v[56:59], v[140:143], a[164:167], v[56:59]
  s_waitcnt lgkmcnt(4)
  v_perm_b32 v136, v121, v120, v100
  v_perm_b32 v137, v123, v122, v100
  v_perm_b32 v138, v125, v124, v100
  v_perm_b32 v139, v127, v126, v100
  v_mfma_f32_16x16x32_bf16 v[52:55], v[140:143], a[44:47], v[52:55]
  v_mfma_f32_16x16x32_bf16 v[60:63], v[140:143], a[172:175], v[60:63]
  ds_read_b128 v[112:115], v99 offset:4128
  ds_read_b128 v[116:119], v99 offset:4384
  v_mfma_f32_16x16x32_bf16 v[48:51], v[136:139], a[48:51], v[48:51]
  v_mfma_f32_16x16x32_bf16 v[56:59], v[136:139], a[176:179], v[56:59]
  s_waitcnt lgkmcnt(4)
  v_perm_b32 v140, v129, v128, v100
  v_perm_b32 v141, v131, v130, v100
  v_perm_b32 v142, v133, v132, v100
  v_perm_b32 v143, v135, v134, v100
  v_mfma_f32_16x16x32_bf16 v[52:55], v[136:139], a[56:59], v[52:55]
  v_mfma_f32_16x16x32_bf16 v[60:63], v[136:139], a[184:187], v[60:63]
  ds_read_b128 v[120:123], v99 offset:5120
  ds_read_b128 v[124:127], v99 offset:5376
  v_mfma_f32_16x16x32_bf16 v[48:51], v[140:143], a[52:55], v[48:51]
  v_mfma_f32_16x16x32_bf16 v[56:59], v[140:143], a[180:183], v[56:59]
  s_waitcnt lgkmcnt(4)
  v_perm_b32 v136, v105, v104, v100
  v_perm_b32 v137, v107, v106, v100
  v_perm_b32 v138, v109, v108, v100
  v_perm_b32 v139, v111, v110, v100
  v_mfma_f32_16x16x32_bf16 v[52:55], v[140:143], a[60:63], v[52:55]
  v_mfma_f32_16x16x32_bf16 v[60:63], v[140:143], a[188:191], v[60:63]
  ds_read_b128 v[128:131], v99 offset:5152
  ds_read_b128 v[132:135], v99 offset:5408
  v_mfma_f32_16x16x32_bf16 v[48:51], v[136:139], a[64:67], v[48:51]
  v_mfma_f32_16x16x32_bf16 v[56:59], v[136:139], a[192:195], v[56:59]
  s_waitcnt lgkmcnt(4)
  v_perm_b32 v140, v113, v112, v100
  v_perm_b32 v141, v115, v114, v100
  v_perm_b32 v142, v117, v116, v100
  v_perm_b32 v143, v119, v118, v100
  v_mfma_f32_16x16x32_bf16 v[52:55], v[136:139], a[72:75], v[52:55]
  v_mfma_f32_16x16x32_bf16 v[60:63], v[136:139], a[200:203], v[60:63]
  ds_read_b128 v[104:107], v99 offset:6144
  ds_read_b128 v[108:111], v99 offset:6400
  v_mfma_f32_16x16x32_bf16 v[48:51], v[140:143], a[68:71], v[48:51]
  v_mfma_f32_16x16x32_bf16 v[56:59], v[140:143], a[196:199], v[56:59]
  s_waitcnt lgkmcnt(4)
  v_perm_b32 v136, v121, v120, v100
  v_perm_b32 v137, v123, v122, v100
  v_perm_b32 v138, v125, v124, v100
  v_perm_b32 v139, v127, v126, v100
  v_mfma_f32_16x16x32_bf16 v[52:55], v[140:143], a[76:79], v[52:55]
  v_mfma_f32_16x16x32_bf16 v[60:63], v[140:143], a[204:207], v[60:63]
  ds_read_b128 v[112:115], v99 offset:6176
  ds_read_b128 v[116:119], v99 offset:6432
  v_mfma_f32_16x16x32_bf16 v[48:51], v[136:139], a[80:83], v[48:51]
  v_mfma_f32_16x16x32_bf16 v[56:59], v[136:139], a[208:211], v[56:59]
  s_waitcnt lgkmcnt(4)
  v_perm_b32 v140, v129, v128, v100
  v_perm_b32 v141, v131, v130, v100
  v_perm_b32 v142, v133, v132, v100
  v_perm_b32 v143, v135, v134, v100
  v_mfma_f32_16x16x32_bf16 v[52:55], v[136:139], a[88:91], v[52:55]
  v_mfma_f32_16x16x32_bf16 v[60:63], v[136:139], a[216:219], v[60:63]
  ds_read_b128 v[120:123], v99 offset:7168
  ds_read_b128 v[124:127], v99 offset:7424
  v_mfma_f32_16x16x32_bf16 v[48:51], v[140:143], a[84:87], v[48:51]
  v_mfma_f32_16x16x32_bf16 v[56:59], v[140:143], a[212:215], v[56:59]
  s_waitcnt lgkmcnt(4)
  v_perm_b32 v136, v105, v104, v100
  v_perm_b32 v137, v107, v106, v100
  v_perm_b32 v138, v109, v108, v100
  v_perm_b32 v139, v111, v110, v100
  v_mfma_f32_16x16x32_bf16 v[52:55], v[140:143], a[92:95], v[52:55]
  v_mfma_f32_16x16x32_bf16 v[60:63], v[140:143], a[220:223], v[60:63]
  ds_read_b128 v[128:131], v99 offset:7200
  ds_read_b128 v[132:135], v99 offset:7456
  v_mfma_f32_16x16x32_bf16 v[48:51], v[136:139], a[96:99], v[48:51]
  v_mfma_f32_16x16x32_bf16 v[56:59], v[136:139], a[224:227], v[56:59]
  s_waitcnt lgkmcnt(4)
  v_perm_b32 v140, v113, v112, v100
  v_perm_b32 v141, v115, v114, v100
  v_perm_b32 v142, v117, v116, v100
  v_perm_b32 v143, v119, v118, v100
  v_mfma_f32_16x16x32_bf16 v[52:55], v[136:139], a[104:107], v[52:55]
  v_mfma_f32_16x16x32_bf16 v[60:63], v[136:139], a[232:235], v[60:63]
  v_mfma_f32_16x16x32_bf16 v[48:51], v[140:143], a[100:103], v[48:51]
  v_mfma_f32_16x16x32_bf16 v[56:59], v[140:143], a[228:231], v[56:59]
  s_waitcnt lgkmcnt(2)
  v_perm_b32 v136, v121, v120, v100
  v_perm_b32 v137, v123, v122, v100
  v_perm_b32 v138, v125, v124, v100
  v_perm_b32 v139, v127, v126, v100
  v_mfma_f32_16x16x32_bf16 v[52:55], v[140:143], a[108:111], v[52:55]
  v_mfma_f32_16x16x32_bf16 v[60:63], v[140:143], a[236:239], v[60:63]
  v_mfma_f32_16x16x32_bf16 v[48:51], v[136:139], a[112:115], v[48:51]
  v_mfma_f32_16x16x32_bf16 v[56:59], v[136:139], a[240:243], v[56:59]
  s_waitcnt lgkmcnt(0)
  v_perm_b32 v140, v129, v128, v100
  v_perm_b32 v141, v131, v130, v100
  v_perm_b32 v142, v133, v132, v100
  v_perm_b32 v143, v135, v134, v100
  v_mfma_f32_16x16x32_bf16 v[52:55], v[136:139], a[120:123], v[52:55]
  v_mfma_f32_16x16x32_bf16 v[60:63], v[136:139], a[248:251], v[60:63]
  v_mfma_f32_16x16x32_bf16 v[48:51], v[140:143], a[116:119], v[48:51]
  v_mfma_f32_16x16x32_bf16 v[56:59], v[140:143], a[244:247], v[56:59]
  v_mfma_f32_16x16x32_bf16 v[52:55], v[140:143], a[124:127], v[52:55]
  v_mfma_f32_16x16x32_bf16 v[60:63], v[140:143], a[252:255], v[60:63]
  s_nop 3
  v_cvt_pk_bf16_f32 v144, v48, v52
  buffer_store_dword v144, v98, s[72:75], s28 offen offset:0 sc1
  v_cvt_pk_bf16_f32 v145, v49, v53
  buffer_store_dword v145, v98, s[72:75], s28 offen offset:256 sc1
  v_cvt_pk_bf16_f32 v148, v56, v57
  v_cvt_pk_bf16_f32 v149, v58, v59
  v_cvt_pk_bf16_f32 v150, v60, v61
  v_cvt_pk_bf16_f32 v151, v62, v63
  buffer_store_dwordx4 v[148:151], v1, s[72:75], s29 offen sc1
  s_add_u32 s26, s26, 2
  s_add_u32 s27, s27, 16384
  s_add_u32 s28, s28, 524288
  s_add_u32 s29, s29, 524288
L_Anext:
  s_cmp_lt_u32 s19, s12
  s_cbranch_scc1 L_A
  s_waitcnt vmcnt(0)
  s_lshr_b32 s10, s26, 1
  v_mov_b32 v4, s10
  s_mov_b64 exec, 1
  buffer_store_dword v4, off, s[72:75], s30 sc1
  s_mov_b64 exec, -1
  s_barrier
  v_mov_b32 v4, s12
  s_cmp_eq_u32 s4, 0
  s_cselect_b64 exec, 1, 0
  buffer_store_dword v4, off, s[72:75], s22 sc1
  s_mov_b64 exec, -1
L_Am:
  s_cmp_gt_u32 s26, 61
  s_cbranch_scc1 L_Ae
  s_cmp_ge_u32 s26, 32
  s_subb_u32 s10, s26, 0
  v_cmp_ge_u32 vcc, s10, v96
  s_cbranch_vccz L_Amc
  s_sleep 4
  buffer_load_dword v96, off, s[72:75], s76 sc1
  s_add_u32 s77, s77, 1
  s_cmp_gt_u32 s77, 200000
  s_cbranch_scc1 L_end
  s_waitcnt vmcnt(0)
  s_branch L_Am
L_Amc:
  s_mov_b32 s77, 0
  s_cmp_lt_u32 s26, 32
  s_cbranch_scc1 L_Amd
  s_add_u32 s10, s27, 4096
  v_add_u32 v97, s31, v1
L_Amp:
  buffer_load_dwordx4 v[16:19], v1, s[72:75], s27 offen offset:0 sc1
  buffer_load_dwordx4 v[20:23], v1, s[72:75], s27 offen offset:1024 sc1
  buffer_load_dwordx4 v[24:27], v1, s[72:75], s27 offen offset:2048 sc1
  buffer_load_dwordx4 v[28:31], v1, s[72:75], s27 offen offset:3072 sc1
  buffer_load_dwordx4 v[32:35], v1, s[72:75], s10 offen offset:0 sc1
  buffer_load_dwordx4 v[36:39], v1, s[72:75], s10 offen offset:1024 sc1
  buffer_load_dwordx4 v[40:43], v1, s[72:75], s10 offen offset:2048 sc1
  buffer_load_dwordx4 v[44:47], v1, s[72:75], s10 offen offset:3072 sc1
  s_add_u32 s77, s77, 1
  s_cmp_gt_u32 s77, 200000
  s_cbranch_scc1 L_end
  s_waitcnt vmcnt(0)
  v_max3_u32 v4, v16, v17, v18
  v_max3_u32 v4, v4, v19, v20
  v_max3_u32 v4, v4, v21, v22
  v_max3_u32 v4, v4, v23, v24
  v_max3_u32 v4, v4, v25, v26
  v_max3_u32 v4, v4, v27, v28
  v_max3_u32 v4, v4, v29, v30
  v_max3_u32 v4, v4, v31, v32
  v_max3_u32 v4, v4, v33, v34
  v_max3_u32 v4, v4, v35, v36
  v_max3_u32 v4, v4, v37, v38
  v_max3_u32 v4, v4, v39, v40
  v_max3_u32 v4, v4, v41, v42
  v_max3_u32 v4, v4, v43, v44
  v_max3_u32 v4, v4, v45, v46
  v_max_u32 v4, v4, v47
  v_cmp_eq_u32 vcc, -1, v4
  s_nop 0
  s_and_b64 exec, exec, vcc
  s_cbranch_scc1 L_Amp
  s_mov_b64 exec, -1
  ds_write_b128 v97, v[16:19] offset:0
  ds_write_b128 v97, v[20:23] offset:1024
  ds_write_b128 v97, v[24:27] offset:2048
  ds_write_b128 v97, v[28:31] offset:3072
  ds_write_b128 v97, v[32:35] offset:4096
  ds_write_b128 v97, v[36:39] offset:5120
  ds_write_b128 v97, v[40:43] offset:6144
  ds_write_b128 v97, v[44:47] offset:7168
  s_branch L_Amk
L_Amd:
  s_add_u32 m0, s31, 0
  s_add_u32 s10, s27, 0
  buffer_load_dwordx4 v1, s[72:75], s10 offen offset:0 sc1 lds
  buffer_load_dwordx4 v1, s[72:75], s10 offen offset:1024 sc1 lds
  buffer_load_dwordx4 v1, s[72:75], s10 offen offset:2048 sc1 lds
  buffer_load_dwordx4 v1, s[72:75], s10 offen offset:3072 sc1 lds
  s_add_u32 m0, s31, 4096
  s_add_u32 s10, s27, 4096
  buffer_load_dwordx4 v1, s[72:75], s10 offen offset:0 sc1 lds
  buffer_load_dwordx4 v1, s[72:75], s10 offen offset:1024 sc1 lds
  buffer_load_dwordx4 v1, s[72:75], s10 offen offset:2048 sc1 lds
  buffer_load_dwordx4 v1, s[72:75], s10 offen offset:3072 sc1 lds
L_Amk:
  s_mov_b32 s77, 0
  s_waitcnt vmcnt(0)
  ds_read_b128 v[104:107], v99 offset:0
  ds_read_b128 v[108:111], v99 offset:256
  ds_read_b128 v[112:115], v99 offset:32
  ds_read_b128 v[116:119], v99 offset:288
  ds_read_b128 v[120:123], v99 offset:1024
  ds_read_b128 v[124:127], v99 offset:1280
  s_waitcnt lgkmcnt(4)
  v_perm_b32 v136, v105, v104, v100
  v_perm_b32 v137, v107, v106, v100
  v_perm_b32 v138, v109, v108, v100
  v_perm_b32 v139, v111, v110, v100
  ds_read_b128 v[128:131], v99 offset:1056
  ds_read_b128 v[132:135], v99 offset:1312
  v_mfma_f32_16x16x32_bf16 v[48:51], v[136:139], a[0:3], 0
  v_mfma_f32_16x16x32_bf16 v[56:59], v[136:139], a[128:131], 0
  s_waitcnt lgkmcnt(4)
  v_perm_b32 v140, v113, v112, v100
  v_perm_b32 v141, v115, v114, v100
  v_perm_b32 v142, v117, v116, v100
  v_perm_b32 v143, v119, v118, v100
  v_mfma_f32_16x16x32_bf16 v[52:55], v[136:139], a[8:11], 0
  v_mfma_f32_16x16x32_bf16 v[60:63], v[136:139], a[136:139], 0
  ds_read_b128 v[104:107], v99 offset:2048
  ds_read_b128 v[108:111], v99 offset:2304
  v_mfma_f32_16x16x32_bf16 v[48:51], v[140:143], a[4:7], v[48:51]
  v_mfma_f32_16x16x32_bf16 v[56:59], v[140:143], a[132:135], v[56:59]
  s_waitcnt lgkmcnt(4)
  v_perm_b32 v136, v121, v120, v100
  v_perm_b32 v137, v123, v122, v100
  v_perm_b32 v138, v125, v124, v100
  v_perm_b32 v139, v127, v126, v100
  v_mfma_f32_16x16x32_bf16 v[52:55], v[140:143], a[12:15], v[52:55]
  v_mfma_f32_16x16x32_bf16 v[60:63], v[140:143], a[140:143], v[60:63]
  ds_read_b128 v[112:115], v99 offset:2080
  ds_read_b128 v[116:119], v99 offset:2336
  v_mfma_f32_16x16x32_bf16 v[48:51], v[136:139], a[16:19], v[48:51]
  v_mfma_f32_16x16x32_bf16 v[56:59], v[136:139], a[144:147], v[56:59]
  s_waitcnt lgkmcnt(4)
  v_perm_b32 v140, v129, v128, v100
  v_perm_b32 v141, v131, v130, v100
  v_perm_b32 v142, v133, v132, v100
  v_perm_b32 v143, v135, v134, v100
  v_mfma_f32_16x16x32_bf16 v[52:55], v[136:139], a[24:27], v[52:55]
  v_mfma_f32_16x16x32_bf16 v[60:63], v[136:139], a[152:155], v[60:63]
  ds_read_b128 v[120:123], v99 offset:3072
  ds_read_b128 v[124:127], v99 offset:3328
  v_mfma_f32_16x16x32_bf16 v[48:51], v[140:143], a[20:23], v[48:51]
  v_mfma_f32_16x16x32_bf16 v[56:59], v[140:143], a[148:151], v[56:59]
  s_waitcnt lgkmcnt(4)
  v_perm_b32 v136, v105, v104, v100
  v_perm_b32 v137, v107, v106, v100
  v_perm_b32 v138, v109, v108, v100
  v_perm_b32 v139, v111, v110, v100
  v_mfma_f32_16x16x32_bf16 v[52:55], v[140:143], a[28:31], v[52:55]
  v_mfma_f32_16x16x32_bf16 v[60:63], v[140:143], a[156:159], v[60:63]
  ds_read_b128 v[128:131], v99 offset:3104
  ds_read_b128 v[132:135], v99 offset:3360
  v_mfma_f32_16x16x32_bf16 v[48:51], v[136:139], a[32:35], v[48:51]
  v_mfma_f32_16x16x32_bf16 v[56:59], v[136:139], a[160:163], v[56:59]
  s_waitcnt lgkmcnt(4)
  v_perm_b32 v140, v113, v112, v100
  v_perm_b32 v141, v115, v114, v100
  v_perm_b32 v142, v117, v116, v100
  v_perm_b32 v143, v119, v118, v100
  v_mfma_f32_16x16x32_bf16 v[52:55], v[136:139], a[40:43], v[52:55]
  v_mfma_f32_16x16x32_bf16 v[60:63], v[136:139], a[168:171], v[60:63]
  ds_read_b128 v[104:107], v99 offset:4096
  ds_read_b128 v[108:111], v99 offset:4352
  v_mfma_f32_16x16x32_bf16 v[48:51], v[140:143], a[36:39], v[48:51]
  v_mfma_f32_16x16x32_bf16 v[56:59], v[140:143], a[164:167], v[56:59]
  s_waitcnt lgkmcnt(4)
  v_perm_b32 v136, v121, v120, v100
  v_perm_b32 v137, v123, v122, v100
  v_perm_b32 v138, v125, v124, v100
  v_perm_b32 v139, v127, v126, v100
  v_mfma_f32_16x16x32_bf16 v[52:55], v[140:143], a[44:47], v[52:55]
  v_mfma_f32_16x16x32_bf16 v[60:63], v[140:143], a[172:175], v[60:63]
  ds_read_b128 v[112:115], v99 offset:4128
  ds_read_b128 v[116:119], v99 offset:4384
  v_mfma_f32_16x16x32_bf16 v[48:51], v[136:139], a[48:51], v[48:51]
  v_mfma_f32_16x16x32_bf16 v[56:59], v[136:139], a[176:179], v[56:59]
  s_waitcnt lgkmcnt(4)
  v_perm_b32 v140, v129, v128, v100
  v_perm_b32 v141, v131, v130, v100
  v_perm_b32 v142, v133, v132, v100
  v_perm_b32 v143, v135, v134, v100
  v_mfma_f32_16x16x32_bf16 v[52:55], v[136:139], a[56:59], v[52:55]
  v_mfma_f32_16x16x32_bf16 v[60:63], v[136:139], a[184:187], v[60:63]
  ds_read_b128 v[120:123], v99 offset:5120
  ds_read_b128 v[124:127], v99 offset:5376
  v_mfma_f32_16x16x32_bf16 v[48:51], v[140:143], a[52:55], v[48:51]
  v_mfma_f32_16x16x32_bf16 v[56:59], v[140:143], a[180:183], v[56:59]
  s_waitcnt lgkmcnt(4)
  v_perm_b32 v136, v105, v104, v100
  v_perm_b32 v137, v107, v106, v100
  v_perm_b32 v138, v109, v108, v100
  v_perm_b32 v139, v111, v110, v100
  v_mfma_f32_16x16x32_bf16 v[52:55], v[140:143], a[60:63], v[52:55]
  v_mfma_f32_16x16x32_bf16 v[60:63], v[140:143], a[188:191], v[60:63]
  ds_read_b128 v[128:131], v99 offset:5152
  ds_read_b128 v[132:135], v99 offset:5408
  v_mfma_f32_16x16x32_bf16 v[48:51], v[136:139], a[64:67], v[48:51]
  v_mfma_f32_16x16x32_bf16 v[56:59], v[136:139], a[192:195], v[56:59]
  s_waitcnt lgkmcnt(4)
  v_perm_b32 v140, v113, v112, v100
  v_perm_b32 v141, v115, v114, v100
  v_perm_b32 v142, v117, v116, v100
  v_perm_b32 v143, v119, v118, v100
  v_mfma_f32_16x16x32_bf16 v[52:55], v[136:139], a[72:75], v[52:55]
  v_mfma_f32_16x16x32_bf16 v[60:63], v[136:139], a[200:203], v[60:63]
  ds_read_b128 v[104:107], v99 offset:6144
  ds_read_b128 v[108:111], v99 offset:6400
  v_mfma_f32_16x16x32_bf16 v[48:51], v[140:143], a[68:71], v[48:51]
  v_mfma_f32_16x16x32_bf16 v[56:59], v[140:143], a[196:199], v[56:59]
  s_waitcnt lgkmcnt(4)
  v_perm_b32 v136, v121, v120, v100
  v_perm_b32 v137, v123, v122, v100
  v_perm_b32 v138, v125, v124, v100
  v_perm_b32 v139, v127, v126, v100
  v_mfma_f32_16x16x32_bf16 v[52:55], v[140:143], a[76:79], v[52:55]
  v_mfma_f32_16x16x32_bf16 v[60:63], v[140:143], a[204:207], v[60:63]
  ds_read_b128 v[112:115], v99 offset:6176
  ds_read_b128 v[116:119], v99 offset:6432
  v_mfma_f32_16x16x32_bf16 v[48:51], v[136:139], a[80:83], v[48:51]
  v_mfma_f32_16x16x32_bf16 v[56:59], v[136:139], a[208:211], v[56:59]
  s_waitcnt lgkmcnt(4)
  v_perm_b32 v140, v129, v128, v100
  v_perm_b32 v141, v131, v130, v100
  v_perm_b32 v142, v133, v132, v100
  v_perm_b32 v143, v135, v134, v100
  v_mfma_f32_16x16x32_bf16 v[52:55], v[136:139], a[88:91], v[52:55]
  v_mfma_f32_16x16x32_bf16 v[60:63], v[136:139], a[216:219], v[60:63]
  ds_read_b128 v[120:123], v99 offset:7168
  ds_read_b128 v[124:127], v99 offset:7424
  v_mfma_f32_16x16x32_bf16 v[48:51], v[140:143], a[84:87], v[48:51]
  v_mfma_f32_16x16x32_bf16 v[56:59], v[140:143], a[212:215], v[56:59]
  s_waitcnt lgkmcnt(4)
  v_perm_b32 v136, v105, v104, v100
  v_perm_b32 v137, v107, v106, v100
  v_perm_b32 v138, v109, v108, v100
  v_perm_b32 v139, v111, v110, v100
  v_mfma_f32_16x16x32_bf16 v[52:55], v[140:143], a[92:95], v[52:55]
  v_mfma_f32_16x16x32_bf16 v[60:63], v[140:143], a[220:223], v[60:63]
  ds_read_b128 v[128:131], v99 offset:7200
  ds_read_b128 v[132:135], v99 offset:7456
  v_mfma_f32_16x16x32_bf16 v[48:51], v[136:139], a[96:99], v[48:51]
  v_mfma_f32_16x16x32_bf16 v[56:59], v[136:139], a[224:227], v[56:59]
  s_waitcnt lgkmcnt(4)
  v_perm_b32 v140, v113, v112, v100
  v_perm_b32 v141, v115, v114, v100
  v_perm_b32 v142, v117, v116, v100
  v_perm_b32 v143, v119, v118, v100
  v_mfma_f32_16x16x32_bf16 v[52:55], v[136:139], a[104:107], v[52:55]
  v_mfma_f32_16x16x32_bf16 v[60:63], v[136:139], a[232:235], v[60:63]
  v_mfma_f32_16x16x32_bf16 v[48:51], v[140:143], a[100:103], v[48:51]
  v_mfma_f32_16x16x32_bf16 v[56:59], v[140:143], a[228:231], v[56:59]
  s_waitcnt lgkmcnt(2)
  v_perm_b32 v136, v121, v120, v100
  v_perm_b32 v137, v123, v122, v100
  v_perm_b32 v138, v125, v124, v100
  v_perm_b32 v139, v127, v126, v100
  v_mfma_f32_16x16x32_bf16 v[52:55], v[140:143], a[108:111], v[52:55]
  v_mfma_f32_16x16x32_bf16 v[60:63], v[140:143], a[236:239], v[60:63]
  v_mfma_f32_16x16x32_bf16 v[48:51], v[136:139], a[112:115], v[48:51]
  v_mfma_f32_16x16x32_bf16 v[56:59], v[136:139], a[240:243], v[56:59]
  s_waitcnt lgkmcnt(0)
  v_perm_b32 v140, v129, v128, v100
  v_perm_b32 v141, v131, v130, v100
  v_perm_b32 v142, v133, v132, v100
  v_perm_b32 v143, v135, v134, v100
  v_mfma_f32_16x16x32_bf16 v[52:55], v[136:139], a[120:123], v[52:55]
  v_mfma_f32_16x16x32_bf16 v[60:63], v[136:139], a[248:251], v[60:63]
  v_mfma_f32_16x16x32_bf16 v[48:51], v[140:143], a[116:119], v[48:51]
  v_mfma_f32_16x16x32_bf16 v[56:59], v[140:143], a[244:247], v[56:59]
  v_mfma_f32_16x16x32_bf16 v[52:55], v[140:143], a[124:127], v[52:55]
  v_mfma_f32_16x16x32_bf16 v[60:63], v[140:143], a[252:255], v[60:63]
  s_nop 3
  v_cvt_pk_bf16_f32 v144, v48, v52
  buffer_store_dword v144, v98, s[72:75], s28 offen offset:0 sc1
  v_cvt_pk_bf16_f32 v145, v49, v53
  buffer_store_dword v145, v98, s[72:75], s28 offen offset:256 sc1
  v_cvt_pk_bf16_f32 v148, v56, v57
  v_cvt_pk_bf16_f32 v149, v58, v59
  v_cvt_pk_bf16_f32 v150, v60, v61
  v_cvt_pk_bf16_f32 v151, v62, v63
  buffer_store_dwordx4 v[148:151], v1, s[72:75], s29 offen sc1
  s_add_u32 s26, s26, 2
  s_add_u32 s27, s27, 16384
  s_add_u32 s28, s28, 524288
  s_add_u32 s29, s29, 524288
  s_waitcnt vmcnt(0)
  s_lshr_b32 s10, s26, 1
  v_mov_b32 v4, s10
  s_mov_b64 exec, 1
  buffer_store_dword v4, off, s[72:75], s30 sc1
  s_mov_b64 exec, -1
  s_branch L_Am
L_Ae:
  s_endpgm
  .p2align 12
L_roleC:
  s_sub_u32 s6, s6, 2
  s_lshl2_add_u32 s7, s5, s6
  s_add_u32 s10, s5, 128
  s_cmp_eq_u32 s6, 4
  s_cselect_b32 s7, s10, s7
  s_mov_b32 s12, 16
  s_cmp_lt_u32 s7, 128
  s_cbranch_scc1 L_nomq
  v_lshrrev_b32 v66, 1, v0
  v_lshlrev_b32 v66, 13, v66
  v_and_b32 v67, 1, v0
  v_lshl_or_b32 v66, v67, 7, v66
  s_and_b32 s10, s7, 3
  s_lshl_b32 s10, s10, 20
  s_and_b32 s11, s7, 28
  s_lshl_b32 s11, s11, 8
  s_add_u32 s11, s11, s10
  buffer_load_dword v68, v66, s[48:51], s11 offen offset:256
  s_waitcnt vmcnt(0)
  s_mov_b32 s14, 0
L_rdy_10:
  buffer_load_dword v4, off, s[68:71], 0 offset:128 sc1
  s_add_u32 s14, s14, 1
  s_cmp_gt_u32 s14, 200000
  s_cbranch_scc1 L_end
  s_waitcnt vmcnt(0)
  v_readfirstlane_b32 s10, v4
  s_nop 0
  s_cmp_eq_u32 s10, 0
  s_cbranch_scc1 L_rdy_10
  s_cmp_lg_u32 s10, s95
  s_cbranch_scc1 L_restart
  s_endpgm
L_nomq:
  s_cmp_ge_u32 s7, 128
  s_cbranch_scc1 L_noln
  v_and_b32 v3, 0x3c, v0
  v_lshlrev_b32 v3, 2, v3
  v_and_b32 v4, 0xc0, v0
  v_lshlrev_b32 v4, 6, v4
  v_xor_b32 v3, v3, v4
  v_and_b32 v4, 0x3, v0
  v_lshlrev_b32 v4, 10, v4
  v_xor_b32 v3, v3, v4
  s_lshl_b32 s10, s7, 14
  buffer_load_dwordx4 v[16:19], v3, s[32:35], s10 offen offset:0
  buffer_load_dwordx4 v[20:23], v3, s[32:35], s10 offen offset:256
  buffer_load_dwordx4 v[24:27], v3, s[32:35], s10 offen offset:512
  buffer_load_dwordx4 v[28:31], v3, s[32:35], s10 offen offset:768
  s_waitcnt vmcnt(0)
  v_lshlrev_b32 v32, 16, v16
  v_and_b32 v33, 0xffff0000, v16
  v_lshlrev_b32 v34, 16, v17
  v_and_b32 v35, 0xffff0000, v17
  v_lshlrev_b32 v36, 16, v18
  v_and_b32 v37, 0xffff0000, v18
  v_lshlrev_b32 v38, 16, v19
  v_and_b32 v39, 0xffff0000, v19
  v_lshlrev_b32 v40, 16, v20
  v_and_b32 v41, 0xffff0000, v20
  v_lshlrev_b32 v42, 16, v21
  v_and_b32 v43, 0xffff0000, v21
  v_lshlrev_b32 v44, 16, v22
  v_and_b32 v45, 0xffff0000, v22
  v_lshlrev_b32 v46, 16, v23
  v_and_b32 v47, 0xffff0000, v23
  v_lshlrev_b32 v48, 16, v24
  v_and_b32 v49, 0xffff0000, v24
  v_lshlrev_b32 v50, 16, v25
  v_and_b32 v51, 0xffff0000, v25
  v_lshlrev_b32 v52, 16, v26
  v_and_b32 v53, 0xffff0000, v26
  v_lshlrev_b32 v54, 16, v27
  v_and_b32 v55, 0xffff0000, v27
  v_lshlrev_b32 v56, 16, v28
  v_and_b32 v57, 0xffff0000, v28
  v_lshlrev_b32 v58, 16, v29
  v_and_b32 v59, 0xffff0000, v29
  v_lshlrev_b32 v60, 16, v30
  v_and_b32 v61, 0xffff0000, v30
  v_lshlrev_b32 v62, 16, v31
  v_and_b32 v63, 0xffff0000, v31
  v_add_f32 v4, v32, v33
  v_add_f32 v5, v34, v35
  v_add_f32 v4, v4, v36
  v_add_f32 v5, v5, v37
  v_add_f32 v4, v4, v38
  v_add_f32 v5, v5, v39
  v_add_f32 v4, v4, v40
  v_add_f32 v5, v5, v41
  v_add_f32 v4, v4, v42
  v_add_f32 v5, v5, v43
  v_add_f32 v4, v4, v44
  v_add_f32 v5, v5, v45
  v_add_f32 v4, v4, v46
  v_add_f32 v5, v5, v47
  v_add_f32 v4, v4, v48
  v_add_f32 v5, v5, v49
  v_add_f32 v4, v4, v50
  v_add_f32 v5, v5, v51
  v_add_f32 v4, v4, v52
  v_add_f32 v5, v5, v53
  v_add_f32 v4, v4, v54
  v_add_f32 v5, v5, v55
  v_add_f32 v4, v4, v56
  v_add_f32 v5, v5, v57
  v_add_f32 v4, v4, v58
  v_add_f32 v5, v5, v59
  v_add_f32 v4, v4, v60
  v_add_f32 v5, v5, v61
  v_add_f32 v4, v4, v62
  v_add_f32 v5, v5, v63
  v_add_f32 v4, v4, v5
  s_nop 1
  v_add_f32_dpp v4, v4, v4 row_ror:4 row_mask:0xf bank_mask:0xf
  s_nop 1
  v_add_f32_dpp v4, v4, v4 row_ror:8 row_mask:0xf bank_mask:0xf
  v_mov_b32 v7, v4
  s_nop 1
  v_permlane16_swap_b32 v4, v7
  v_add_f32 v4, v4, v7
  v_mov_b32 v7, v4
  s_nop 1
  v_permlane32_swap_b32 v4, v7
  v_add_f32 v4, v4, v7
  v_mul_f32 v4, 0x3b000000, v4
  v_mov_b32 v5, 0
  v_mov_b32 v6, 0
  v_sub_f32 v64, v32, v4
  v_sub_f32 v65, v33, v4
  v_fmac_f32 v5, v64, v64
  v_fmac_f32 v6, v65, v65
  v_sub_f32 v64, v34, v4
  v_sub_f32 v65, v35, v4
  v_fmac_f32 v5, v64, v64
  v_fmac_f32 v6, v65, v65
  v_sub_f32 v64, v36, v4
  v_sub_f32 v65, v37, v4
  v_fmac_f32 v5, v64, v64
  v_fmac_f32 v6, v65, v65
  v_sub_f32 v64, v38, v4
  v_sub_f32 v65, v39, v4
  v_fmac_f32 v5, v64, v64
  v_fmac_f32 v6, v65, v65
  v_sub_f32 v64, v40, v4
  v_sub_f32 v65, v41, v4
  v_fmac_f32 v5, v64, v64
  v_fmac_f32 v6, v65, v65
  v_sub_f32 v64, v42, v4
  v_sub_f32 v65, v43, v4
  v_fmac_f32 v5, v64, v64
  v_fmac_f32 v6, v65, v65
  v_sub_f32 v64, v44, v4
  v_sub_f32 v65, v45, v4
  v_fmac_f32 v5, v64, v64
  v_fmac_f32 v6, v65, v65
  v_sub_f32 v64, v46, v4
  v_sub_f32 v65, v47, v4
  v_fmac_f32 v5, v64, v64
  v_fmac_f32 v6, v65, v65
  v_sub_f32 v64, v48, v4
  v_sub_f32 v65, v49, v4
  v_fmac_f32 v5, v64, v64
  v_fmac_f32 v6, v65, v65
  v_sub_f32 v64, v50, v4
  v_sub_f32 v65, v51, v4
  v_fmac_f32 v5, v64, v64
  v_fmac_f32 v6, v65, v65
  v_sub_f32 v64, v52, v4
  v_sub_f32 v65, v53, v4
  v_fmac_f32 v5, v64, v64
  v_fmac_f32 v6, v65, v65
  v_sub_f32 v64, v54, v4
  v_sub_f32 v65, v55, v4
  v_fmac_f32 v5, v64, v64
  v_fmac_f32 v6, v65, v65
  v_sub_f32 v64, v56, v4
  v_sub_f32 v65, v57, v4
  v_fmac_f32 v5, v64, v64
  v_fmac_f32 v6, v65, v65
  v_sub_f32 v64, v58, v4
  v_sub_f32 v65, v59, v4
  v_fmac_f32 v5, v64, v64
  v_fmac_f32 v6, v65, v65
  v_sub_f32 v64, v60, v4
  v_sub_f32 v65, v61, v4
  v_fmac_f32 v5, v64, v64
  v_fmac_f32 v6, v65, v65
  v_sub_f32 v64, v62, v4
  v_sub_f32 v65, v63, v4
  v_fmac_f32 v5, v64, v64
  v_fmac_f32 v6, v65, v65
  v_add_f32 v5, v5, v6
  s_nop 1
  v_add_f32_dpp v5, v5, v5 row_ror:4 row_mask:0xf bank_mask:0xf
  s_nop 1
  v_add_f32_dpp v5, v5, v5 row_ror:8 row_mask:0xf bank_mask:0xf
  v_mov_b32 v7, v5
  s_nop 1
  v_permlane16_swap_b32 v5, v7
  v_add_f32 v5, v5, v7
  v_mov_b32 v7, v5
  s_nop 1
  v_permlane32_swap_b32 v5, v7
  v_add_f32 v5, v5, v7
  v_mul_f32 v5, 0x3b000000, v5
  v_cvt_pk_bf16_f32 v4, v4, v5
  v_and_b32 v5, 0xffff0000, v4
  v_lshlrev_b32 v4, 16, v4
  v_add_f32 v5, 0x3727c5ac, v5
  v_cvt_pk_bf16_f32 v5, v5, v5
  v_lshlrev_b32 v5, 16, v5
  v_sqrt_f32 v5, v5
  s_nop 0
  v_cvt_pk_bf16_f32 v5, v5, v5
  v_lshlrev_b32 v5, 16, v5
  v_rcp_f32 v6, v5
  v_sub_f32 v32, v32, v4
  v_sub_f32 v33, v33, v4
  v_cvt_pk_bf16_f32 v32, v32, v33
  v_and_b32 v33, 0xffff0000, v32
  v_lshlrev_b32 v32, 16, v32
  v_mul_f32 v64, v32, v6
  v_mul_f32 v65, v33, v6
  v_fma_f32 v32, -v64, v5, v32
  v_fma_f32 v33, -v65, v5, v33
  v_fmac_f32 v64, v32, v6
  v_fmac_f32 v65, v33, v6
  v_cvt_pk_bf16_f32 v16, v64, v65
  v_sub_f32 v34, v34, v4
  v_sub_f32 v35, v35, v4
  v_cvt_pk_bf16_f32 v34, v34, v35
  v_and_b32 v35, 0xffff0000, v34
  v_lshlrev_b32 v34, 16, v34
  v_mul_f32 v64, v34, v6
  v_mul_f32 v65, v35, v6
  v_fma_f32 v34, -v64, v5, v34
  v_fma_f32 v35, -v65, v5, v35
  v_fmac_f32 v64, v34, v6
  v_fmac_f32 v65, v35, v6
  v_cvt_pk_bf16_f32 v17, v64, v65
  v_sub_f32 v36, v36, v4
  v_sub_f32 v37, v37, v4
  v_cvt_pk_bf16_f32 v36, v36, v37
  v_and_b32 v37, 0xffff0000, v36
  v_lshlrev_b32 v36, 16, v36
  v_mul_f32 v64, v36, v6
  v_mul_f32 v65, v37, v6
  v_fma_f32 v36, -v64, v5, v36
  v_fma_f32 v37, -v65, v5, v37
  v_fmac_f32 v64, v36, v6
  v_fmac_f32 v65, v37, v6
  v_cvt_pk_bf16_f32 v18, v64, v65
  v_sub_f32 v38, v38, v4
  v_sub_f32 v39, v39, v4
  v_cvt_pk_bf16_f32 v38, v38, v39
  v_and_b32 v39, 0xffff0000, v38
  v_lshlrev_b32 v38, 16, v38
  v_mul_f32 v64, v38, v6
  v_mul_f32 v65, v39, v6
  v_fma_f32 v38, -v64, v5, v38
  v_fma_f32 v39, -v65, v5, v39
  v_fmac_f32 v64, v38, v6
  v_fmac_f32 v65, v39, v6
  v_cvt_pk_bf16_f32 v19, v64, v65
  v_sub_f32 v40, v40, v4
  v_sub_f32 v41, v41, v4
  v_cvt_pk_bf16_f32 v40, v40, v41
  v_and_b32 v41, 0xffff0000, v40
  v_lshlrev_b32 v40, 16, v40
  v_mul_f32 v64, v40, v6
  v_mul_f32 v65, v41, v6
  v_fma_f32 v40, -v64, v5, v40
  v_fma_f32 v41, -v65, v5, v41
  v_fmac_f32 v64, v40, v6
  v_fmac_f32 v65, v41, v6
  v_cvt_pk_bf16_f32 v20, v64, v65
  v_sub_f32 v42, v42, v4
  v_sub_f32 v43, v43, v4
  v_cvt_pk_bf16_f32 v42, v42, v43
  v_and_b32 v43, 0xffff0000, v42
  v_lshlrev_b32 v42, 16, v42
  v_mul_f32 v64, v42, v6
  v_mul_f32 v65, v43, v6
  v_fma_f32 v42, -v64, v5, v42
  v_fma_f32 v43, -v65, v5, v43
  v_fmac_f32 v64, v42, v6
  v_fmac_f32 v65, v43, v6
  v_cvt_pk_bf16_f32 v21, v64, v65
  v_sub_f32 v44, v44, v4
  v_sub_f32 v45, v45, v4
  v_cvt_pk_bf16_f32 v44, v44, v45
  v_and_b32 v45, 0xffff0000, v44
  v_lshlrev_b32 v44, 16, v44
  v_mul_f32 v64, v44, v6
  v_mul_f32 v65, v45, v6
  v_fma_f32 v44, -v64, v5, v44
  v_fma_f32 v45, -v65, v5, v45
  v_fmac_f32 v64, v44, v6
  v_fmac_f32 v65, v45, v6
  v_cvt_pk_bf16_f32 v22, v64, v65
  v_sub_f32 v46, v46, v4
  v_sub_f32 v47, v47, v4
  v_cvt_pk_bf16_f32 v46, v46, v47
  v_and_b32 v47, 0xffff0000, v46
  v_lshlrev_b32 v46, 16, v46
  v_mul_f32 v64, v46, v6
  v_mul_f32 v65, v47, v6
  v_fma_f32 v46, -v64, v5, v46
  v_fma_f32 v47, -v65, v5, v47
  v_fmac_f32 v64, v46, v6
  v_fmac_f32 v65, v47, v6
  v_cvt_pk_bf16_f32 v23, v64, v65
  v_sub_f32 v48, v48, v4
  v_sub_f32 v49, v49, v4
  v_cvt_pk_bf16_f32 v48, v48, v49
  v_and_b32 v49, 0xffff0000, v48
  v_lshlrev_b32 v48, 16, v48
  v_mul_f32 v64, v48, v6
  v_mul_f32 v65, v49, v6
  v_fma_f32 v48, -v64, v5, v48
  v_fma_f32 v49, -v65, v5, v49
  v_fmac_f32 v64, v48, v6
  v_fmac_f32 v65, v49, v6
  v_cvt_pk_bf16_f32 v24, v64, v65
  v_sub_f32 v50, v50, v4
  v_sub_f32 v51, v51, v4
  v_cvt_pk_bf16_f32 v50, v50, v51
  v_and_b32 v51, 0xffff0000, v50
  v_lshlrev_b32 v50, 16, v50
  v_mul_f32 v64, v50, v6
  v_mul_f32 v65, v51, v6
  v_fma_f32 v50, -v64, v5, v50
  v_fma_f32 v51, -v65, v5, v51
  v_fmac_f32 v64, v50, v6
  v_fmac_f32 v65, v51, v6
  v_cvt_pk_bf16_f32 v25, v64, v65
  v_sub_f32 v52, v52, v4
  v_sub_f32 v53, v53, v4
  v_cvt_pk_bf16_f32 v52, v52, v53
  v_and_b32 v53, 0xffff0000, v52
  v_lshlrev_b32 v52, 16, v52
  v_mul_f32 v64, v52, v6
  v_mul_f32 v65, v53, v6
  v_fma_f32 v52, -v64, v5, v52
  v_fma_f32 v53, -v65, v5, v53
  v_fmac_f32 v64, v52, v6
  v_fmac_f32 v65, v53, v6
  v_cvt_pk_bf16_f32 v26, v64, v65
  v_sub_f32 v54, v54, v4
  v_sub_f32 v55, v55, v4
  v_cvt_pk_bf16_f32 v54, v54, v55
  v_and_b32 v55, 0xffff0000, v54
  v_lshlrev_b32 v54, 16, v54
  v_mul_f32 v64, v54, v6
  v_mul_f32 v65, v55, v6
  v_fma_f32 v54, -v64, v5, v54
  v_fma_f32 v55, -v65, v5, v55
  v_fmac_f32 v64, v54, v6
  v_fmac_f32 v65, v55, v6
  v_cvt_pk_bf16_f32 v27, v64, v65
  v_sub_f32 v56, v56, v4
  v_sub_f32 v57, v57, v4
  v_cvt_pk_bf16_f32 v56, v56, v57
  v_and_b32 v57, 0xffff0000, v56
  v_lshlrev_b32 v56, 16, v56
  v_mul_f32 v64, v56, v6
  v_mul_f32 v65, v57, v6
  v_fma_f32 v56, -v64, v5, v56
  v_fma_f32 v57, -v65, v5, v57
  v_fmac_f32 v64, v56, v6
  v_fmac_f32 v65, v57, v6
  v_cvt_pk_bf16_f32 v28, v64, v65
  v_sub_f32 v58, v58, v4
  v_sub_f32 v59, v59, v4
  v_cvt_pk_bf16_f32 v58, v58, v59
  v_and_b32 v59, 0xffff0000, v58
  v_lshlrev_b32 v58, 16, v58
  v_mul_f32 v64, v58, v6
  v_mul_f32 v65, v59, v6
  v_fma_f32 v58, -v64, v5, v58
  v_fma_f32 v59, -v65, v5, v59
  v_fmac_f32 v64, v58, v6
  v_fmac_f32 v65, v59, v6
  v_cvt_pk_bf16_f32 v29, v64, v65
  v_sub_f32 v60, v60, v4
  v_sub_f32 v61, v61, v4
  v_cvt_pk_bf16_f32 v60, v60, v61
  v_and_b32 v61, 0xffff0000, v60
  v_lshlrev_b32 v60, 16, v60
  v_mul_f32 v64, v60, v6
  v_mul_f32 v65, v61, v6
  v_fma_f32 v60, -v64, v5, v60
  v_fma_f32 v61, -v65, v5, v61
  v_fmac_f32 v64, v60, v6
  v_fmac_f32 v65, v61, v6
  v_cvt_pk_bf16_f32 v30, v64, v65
  v_sub_f32 v62, v62, v4
  v_sub_f32 v63, v63, v4
  v_cvt_pk_bf16_f32 v62, v62, v63
  v_and_b32 v63, 0xffff0000, v62
  v_lshlrev_b32 v62, 16, v62
  v_mul_f32 v64, v62, v6
  v_mul_f32 v65, v63, v6
  v_fma_f32 v62, -v64, v5, v62
  v_fma_f32 v63, -v65, v5, v63
  v_fmac_f32 v64, v62, v6
  v_fmac_f32 v65, v63, v6
  v_cvt_pk_bf16_f32 v31, v64, v65
  v_and_b32 v3, 0xc0, v0
  v_and_b32 v4, 0x3, v0
  v_lshlrev_b32 v4, 4, v4
  v_xor_b32 v3, v3, v4
  v_and_b32 v4, 0x3c, v0
  v_lshlrev_b32 v4, 6, v4
  v_xor_b32 v3, v3, v4
  s_lshl_b32 s10, s7, 14
  s_add_u32 s10, s10, 0x100000
  buffer_store_dwordx4 v[16:19], v3, s[72:75], s10 offen sc1
  s_add_u32 s10, s10, 4096
  buffer_store_dwordx4 v[20:23], v3, s[72:75], s10 offen sc1
  s_add_u32 s10, s10, 4096
  buffer_store_dwordx4 v[24:27], v3, s[72:75], s10 offen sc1
  s_add_u32 s10, s10, 4096
  buffer_store_dwordx4 v[28:31], v3, s[72:75], s10 offen sc1
  s_mov_b32 s14, 0
L_rdy_11:
  buffer_load_dword v4, off, s[68:71], 0 offset:128 sc1
  s_add_u32 s14, s14, 1
  s_cmp_gt_u32 s14, 200000
  s_cbranch_scc1 L_end
  s_waitcnt vmcnt(0)
  v_readfirstlane_b32 s10, v4
  s_nop 0
  s_cmp_eq_u32 s10, 0
  s_cbranch_scc1 L_rdy_11
  s_cmp_lg_u32 s10, s95
  s_cbranch_scc1 L_restart
  s_barrier
  s_lshl_b32 s10, s7, 2
  v_mov_b32 v4, 1
  s_cmp_eq_u32 s4, 0
  s_cselect_b64 exec, 1, 0
  buffer_store_dword v4, off, s[72:75], s10 offset:0 sc1
  s_mov_b64 exec, -1
L_noln:
  v_and_b32 v10, 0xc0, v0
  v_and_b32 v11, 0x1f, v0
  v_lshlrev_b32 v11, 3, v11
  v_xor_b32 v10, v10, v11
  v_and_b32 v11, 0x2c, v0
  v_lshlrev_b32 v11, 6, v11
  v_xor_b32 v10, v10, v11
  v_and_b32 v11, 0x10, v0
  v_lshlrev_b32 v11, 8, v11
  v_xor_b32 v10, v10, v11
  v_xor_b32 v11, 32, v10
  v_add_u32 v12, 0x10000, v10
  v_add_u32 v13, 0x10000, v11
  v_add_u32 v14, 0x20000, v10
  v_add_u32 v15, 0x20000, v11
  v_and_b32 v16, 0x10, v0
  v_lshlrev_b32 v16, 1, v16
  v_and_b32 v17, 0x60, v0
  v_lshlrev_b32 v17, 3, v17
  v_xor_b32 v16, v16, v17
  v_and_b32 v17, 0x3, v0
  v_lshlrev_b32 v17, 4, v17
  v_xor_b32 v16, v16, v17
  v_and_b32 v17, 0x7c, v0
  v_lshlrev_b32 v17, 6, v17
  v_xor_b32 v16, v16, v17
  v_and_b32 v17, 0x80, v0
  v_lshlrev_b32 v17, 8, v17
  v_xor_b32 v16, v16, v17
  v_and_b32 v17, 0x18, v0
  v_lshrrev_b32 v17, 3, v17
  v_and_b32 v18, 0x20, v0
  v_lshrrev_b32 v18, 2, v18
  v_xor_b32 v17, v17, v18
  v_and_b32 v18, 0xc0, v0
  v_lshrrev_b32 v18, 1, v18
  v_xor_b32 v17, v17, v18
  v_and_b32 v18, 0x30, v0
  v_lshlrev_b32 v18, 1, v18
  v_and_b32 v19, 0x7, v0
  v_lshlrev_b32 v19, 4, v19
  v_xor_b32 v18, v18, v19
  s_movk_i32 s10, 3584
  v_mul_u32_u24 v17, s10, v17
  v_add_u32 v17, v17, v18
  s_lshl_b32 s14, s5, 17
  s_mul_i32 s16, s5, 57344
  s_mul_i32 s17, s5, 112
  s_add_u32 m0, s9, 0x0
  s_add_u32 s10, s13, 0x0
  buffer_load_dwordx4 v8, s[40:43], s10 offen lds
  s_add_u32 m0, s9, 0x400
  s_add_u32 s10, s13, 0x8000
  buffer_load_dwordx4 v8, s[40:43], s10 offen lds
  s_add_u32 m0, s9, 0x800
  s_add_u32 s10, s13, 0x20000
  buffer_load_dwordx4 v8, s[40:43], s10 offen lds
  s_add_u32 m0, s9, 0xc00
  s_add_u32 s10, s13, 0x28000
  buffer_load_dwordx4 v8, s[40:43], s10 offen lds
  s_add_u32 m0, s9, 0x4000
  s_add_u32 s10, s13, 0x80000
  buffer_load_dwordx4 v8, s[40:43], s10 offen lds
  s_add_u32 m0, s9, 0x4400
  s_add_u32 s10, s13, 0x88000
  buffer_load_dwordx4 v8, s[40:43], s10 offen lds
  s_add_u32 m0, s9, 0x4800
  s_add_u32 s10, s13, 0xa0000
  buffer_load_dwordx4 v8, s[40:43], s10 offen lds
  s_add_u32 m0, s9, 0x4c00
  s_add_u32 s10, s13, 0xa8000
  buffer_load_dwordx4 v8, s[40:43], s10 offen lds
  s_add_u32 m0, s9, 0x8000
  s_add_u32 s10, s13, 0x100000
  buffer_load_dwordx4 v8, s[40:43], s10 offen lds
  s_add_u32 m0, s9, 0x8400
  s_add_u32 s10, s13, 0x108000
  buffer_load_dwordx4 v8, s[40:43], s10 offen lds
  s_add_u32 m0, s9, 0x8800
  s_add_u32 s10, s13, 0x120000
  buffer_load_dwordx4 v8, s[40:43], s10 offen lds
  s_add_u32 m0, s9, 0x8c00
  s_add_u32 s10, s13, 0x128000
  buffer_load_dwordx4 v8, s[40:43], s10 offen lds
  s_add_u32 m0, s9, 0xc000
  s_add_u32 s10, s13, 0x180000
  buffer_load_dwordx4 v8, s[40:43], s10 offen lds
  s_add_u32 m0, s9, 0xc400
  s_add_u32 s10, s13, 0x188000
  buffer_load_dwordx4 v8, s[40:43], s10 offen lds
  s_add_u32 m0, s9, 0xc800
  s_add_u32 s10, s13, 0x1a0000
  buffer_load_dwordx4 v8, s[40:43], s10 offen lds
  s_add_u32 m0, s9, 0xcc00
  s_add_u32 s10, s13, 0x1a8000
  buffer_load_dwordx4 v8, s[40:43], s10 offen lds
  s_add_u32 m0, s9, 0x10000
  s_add_u32 s10, s13, 0x200000
  buffer_load_dwordx4 v8, s[40:43], s10 offen lds
  s_add_u32 m0, s9, 0x10400
  s_add_u32 s10, s13, 0x208000
  buffer_load_dwordx4 v8, s[40:43], s10 offen lds
  s_add_u32 m0, s9, 0x10800
  s_add_u32 s10, s13, 0x220000
  buffer_load_dwordx4 v8, s[40:43], s10 offen lds
  s_add_u32 m0, s9, 0x10c00
  s_add_u32 s10, s13, 0x228000
  buffer_load_dwordx4 v8, s[40:43], s10 offen lds
  s_add_u32 m0, s9, 0x14000
  s_add_u32 s10, s13, 0x280000
  buffer_load_dwordx4 v8, s[40:43], s10 offen lds
  s_add_u32 m0, s9, 0x14400
  s_add_u32 s10, s13, 0x288000
  buffer_load_dwordx4 v8, s[40:43], s10 offen lds
  s_add_u32 m0, s9, 0x14800
  s_add_u32 s10, s13, 0x2a0000
  buffer_load_dwordx4 v8, s[40:43], s10 offen lds
  s_add_u32 m0, s9, 0x14c00
  s_add_u32 s10, s13, 0x2a8000
  buffer_load_dwordx4 v8, s[40:43], s10 offen lds
  s_add_u32 m0, s9, 0x18000
  s_add_u32 s10, s13, 0x300000
  buffer_load_dwordx4 v8, s[40:43], s10 offen lds
  s_add_u32 m0, s9, 0x18400
  s_add_u32 s10, s13, 0x308000
  buffer_load_dwordx4 v8, s[40:43], s10 offen lds
  s_add_u32 m0, s9, 0x18800
  s_add_u32 s10, s13, 0x320000
  buffer_load_dwordx4 v8, s[40:43], s10 offen lds
  s_add_u32 m0, s9, 0x18c00
  s_add_u32 s10, s13, 0x328000
  buffer_load_dwordx4 v8, s[40:43], s10 offen lds
  s_add_u32 m0, s9, 0x1c000
  s_add_u32 s10, s13, 0x380000
  buffer_load_dwordx4 v8, s[40:43], s10 offen lds
  s_add_u32 m0, s9, 0x1c400
  s_add_u32 s10, s13, 0x388000
  buffer_load_dwordx4 v8, s[40:43], s10 offen lds
  s_add_u32 m0, s9, 0x1c800
  s_add_u32 s10, s13, 0x3a0000
  buffer_load_dwordx4 v8, s[40:43], s10 offen lds
  s_add_u32 m0, s9, 0x1cc00
  s_add_u32 s10, s13, 0x3a8000
  buffer_load_dwordx4 v8, s[40:43], s10 offen lds
  s_add_u32 m0, s9, 0x20000
  s_add_u32 s10, s16, 0x0
  buffer_load_dwordx4 v16, s[60:63], s10 offen lds
  s_add_u32 m0, s9, 0x20400
  s_add_u32 s10, s16, 0x4000
  buffer_load_dwordx4 v16, s[60:63], s10 offen lds
  s_add_u32 m0, s9, 0x20800
  s_add_u32 s10, s16, 0x2000
  buffer_load_dwordx4 v16, s[60:63], s10 offen lds
  s_add_u32 m0, s9, 0x20c00
  s_add_u32 s10, s16, 0x6000
  s_cmp_ge_u32 s4, 2
  s_cselect_b32 s10, 0x40000000, s10
  buffer_load_dwordx4 v16, s[60:63], s10 offen lds
  s_add_u32 m0, s9, 0x24000
  s_add_u32 s10, s16, 0x40
  buffer_load_dwordx4 v16, s[60:63], s10 offen lds
  s_add_u32 m0, s9, 0x24400
  s_add_u32 s10, s16, 0x4040
  buffer_load_dwordx4 v16, s[60:63], s10 offen lds
  s_add_u32 m0, s9, 0x24800
  s_add_u32 s10, s16, 0x2040
  buffer_load_dwordx4 v16, s[60:63], s10 offen lds
  s_add_u32 m0, s9, 0x24c00
  s_add_u32 s10, s16, 0x6040
  s_cmp_ge_u32 s4, 2
  s_cselect_b32 s10, 0x40000000, s10
  buffer_load_dwordx4 v16, s[60:63], s10 offen lds
  s_waitcnt vmcnt(0)
  s_barrier
  ds_read_b64_tr_b16 a[0:1], v10 offset:0
  ds_read_b64_tr_b16 a[2:3], v10 offset:1024
  ds_read_b64_tr_b16 a[4:5], v10 offset:8192
  ds_read_b64_tr_b16 a[6:7], v10 offset:9216
  ds_read_b64_tr_b16 a[8:9], v11 offset:0
  ds_read_b64_tr_b16 a[10:11], v11 offset:1024
  ds_read_b64_tr_b16 a[12:13], v11 offset:8192
  ds_read_b64_tr_b16 a[14:15], v11 offset:9216
  ds_read_b64_tr_b16 a[16:17], v10 offset:16384
  ds_read_b64_tr_b16 a[18:19], v10 offset:17408
  ds_read_b64_tr_b16 a[20:21], v10 offset:24576
  ds_read_b64_tr_b16 a[22:23], v10 offset:25600
  ds_read_b64_tr_b16 a[24:25], v11 offset:16384
  ds_read_b64_tr_b16 a[26:27], v11 offset:17408
  ds_read_b64_tr_b16 a[28:29], v11 offset:24576
  ds_read_b64_tr_b16 a[30:31], v11 offset:25600
  ds_read_b64_tr_b16 a[32:33], v10 offset:32768
  ds_read_b64_tr_b16 a[34:35], v10 offset:33792
  ds_read_b64_tr_b16 a[36:37], v10 offset:40960
  ds_read_b64_tr_b16 a[38:39], v10 offset:41984
  ds_read_b64_tr_b16 a[40:41], v11 offset:32768
  ds_read_b64_tr_b16 a[42:43], v11 offset:33792
  ds_read_b64_tr_b16 a[44:45], v11 offset:40960
  ds_read_b64_tr_b16 a[46:47], v11 offset:41984
  ds_read_b64_tr_b16 a[48:49], v10 offset:49152
  ds_read_b64_tr_b16 a[50:51], v10 offset:50176
  ds_read_b64_tr_b16 a[52:53], v10 offset:57344
  ds_read_b64_tr_b16 a[54:55], v10 offset:58368
  ds_read_b64_tr_b16 a[56:57], v11 offset:49152
  ds_read_b64_tr_b16 a[58:59], v11 offset:50176
  ds_read_b64_tr_b16 a[60:61], v11 offset:57344
  ds_read_b64_tr_b16 a[62:63], v11 offset:58368
  ds_read_b64_tr_b16 a[64:65], v12 offset:0
  ds_read_b64_tr_b16 a[66:67], v12 offset:1024
  ds_read_b64_tr_b16 a[68:69], v12 offset:8192
  ds_read_b64_tr_b16 a[70:71], v12 offset:9216
  ds_read_b64_tr_b16 a[72:73], v13 offset:0
  ds_read_b64_tr_b16 a[74:75], v13 offset:1024
  ds_read_b64_tr_b16 a[76:77], v13 offset:8192
  ds_read_b64_tr_b16 a[78:79], v13 offset:9216
  ds_read_b64_tr_b16 a[80:81], v12 offset:16384
  ds_read_b64_tr_b16 a[82:83], v12 offset:17408
  ds_read_b64_tr_b16 a[84:85], v12 offset:24576
  ds_read_b64_tr_b16 a[86:87], v12 offset:25600
  ds_read_b64_tr_b16 a[88:89], v13 offset:16384
  ds_read_b64_tr_b16 a[90:91], v13 offset:17408
  ds_read_b64_tr_b16 a[92:93], v13 offset:24576
  ds_read_b64_tr_b16 a[94:95], v13 offset:25600
  ds_read_b64_tr_b16 a[96:97], v12 offset:32768
  ds_read_b64_tr_b16 a[98:99], v12 offset:33792
  ds_read_b64_tr_b16 a[100:101], v12 offset:40960
  ds_read_b64_tr_b16 a[102:103], v12 offset:41984
  ds_read_b64_tr_b16 a[104:105], v13 offset:32768
  ds_read_b64_tr_b16 a[106:107], v13 offset:33792
  ds_read_b64_tr_b16 a[108:109], v13 offset:40960
  ds_read_b64_tr_b16 a[110:111], v13 offset:41984
  ds_read_b64_tr_b16 a[112:113], v12 offset:49152
  ds_read_b64_tr_b16 a[114:115], v12 offset:50176
  ds_read_b64_tr_b16 a[116:117], v12 offset:57344
  ds_read_b64_tr_b16 a[118:119], v12 offset:58368
  ds_read_b64_tr_b16 a[120:121], v13 offset:49152
  ds_read_b64_tr_b16 a[122:123], v13 offset:50176
  ds_read_b64_tr_b16 a[124:125], v13 offset:57344
  ds_read_b64_tr_b16 a[126:127], v13 offset:58368
  ds_read_b64_tr_b16 v[192:193], v14 offset:0
  ds_read_b64_tr_b16 v[194:195], v14 offset:1024
  ds_read_b64_tr_b16 v[196:197], v14 offset:8192
  ds_read_b64_tr_b16 v[198:199], v14 offset:9216
  ds_read_b64_tr_b16 v[200:201], v15 offset:0
  ds_read_b64_tr_b16 v[202:203], v15 offset:1024
  ds_read_b64_tr_b16 v[204:205], v15 offset:8192
  ds_read_b64_tr_b16 v[206:207], v15 offset:9216
  ds_read_b64_tr_b16 v[208:209], v14 offset:16384
  ds_read_b64_tr_b16 v[210:211], v14 offset:17408
  ds_read_b64_tr_b16 v[212:213], v14 offset:24576
  ds_read_b64_tr_b16 v[214:215], v14 offset:25600
  ds_read_b64_tr_b16 v[216:217], v15 offset:16384
  ds_read_b64_tr_b16 v[218:219], v15 offset:17408
  ds_read_b64_tr_b16 v[220:221], v15 offset:24576
  ds_read_b64_tr_b16 v[222:223], v15 offset:25600
  s_waitcnt lgkmcnt(0)
  s_barrier
  s_add_u32 m0, s9, 0x0
  s_add_u32 s10, s14, 0x0
  buffer_load_dwordx4 v16, s[52:55], s10 offen lds
  s_add_u32 m0, s9, 0x400
  s_add_u32 s10, s14, 0x4000
  buffer_load_dwordx4 v16, s[52:55], s10 offen lds
  s_add_u32 m0, s9, 0x800
  s_add_u32 s10, s14, 0x2000
  buffer_load_dwordx4 v16, s[52:55], s10 offen lds
  s_add_u32 m0, s9, 0xc00
  s_add_u32 s10, s14, 0x6000
  buffer_load_dwordx4 v16, s[52:55], s10 offen lds
  s_add_u32 m0, s9, 0x4000
  s_add_u32 s10, s14, 0x40
  buffer_load_dwordx4 v16, s[52:55], s10 offen lds
  s_add_u32 m0, s9, 0x4400
  s_add_u32 s10, s14, 0x4040
  buffer_load_dwordx4 v16, s[52:55], s10 offen lds
  s_add_u32 m0, s9, 0x4800
  s_add_u32 s10, s14, 0x2040
  buffer_load_dwordx4 v16, s[52:55], s10 offen lds
  s_add_u32 m0, s9, 0x4c00
  s_add_u32 s10, s14, 0x6040
  buffer_load_dwordx4 v16, s[52:55], s10 offen lds
  s_add_u32 m0, s9, 0x8000
  s_add_u32 s10, s14, 0x80
  buffer_load_dwordx4 v16, s[52:55], s10 offen lds
  s_add_u32 m0, s9, 0x8400
  s_add_u32 s10, s14, 0x4080
  buffer_load_dwordx4 v16, s[52:55], s10 offen lds
  s_add_u32 m0, s9, 0x8800
  s_add_u32 s10, s14, 0x2080
  buffer_load_dwordx4 v16, s[52:55], s10 offen lds
  s_add_u32 m0, s9, 0x8c00
  s_add_u32 s10, s14, 0x6080
  buffer_load_dwordx4 v16, s[52:55], s10 offen lds
  s_add_u32 m0, s9, 0xc000
  s_add_u32 s10, s14, 0xc0
  buffer_load_dwordx4 v16, s[52:55], s10 offen lds
  s_add_u32 m0, s9, 0xc400
  s_add_u32 s10, s14, 0x40c0
  buffer_load_dwordx4 v16, s[52:55], s10 offen lds
  s_add_u32 m0, s9, 0xc800
  s_add_u32 s10, s14, 0x20c0
  buffer_load_dwordx4 v16, s[52:55], s10 offen lds
  s_add_u32 m0, s9, 0xcc00
  s_add_u32 s10, s14, 0x60c0
  buffer_load_dwordx4 v16, s[52:55], s10 offen lds
  s_add_u32 m0, s9, 0x10000
  s_add_u32 s10, s14, 0x10000
  buffer_load_dwordx4 v16, s[52:55], s10 offen lds
  s_add_u32 m0, s9, 0x10400
  s_add_u32 s10, s14, 0x14000
  buffer_load_dwordx4 v16, s[52:55], s10 offen lds
  s_add_u32 m0, s9, 0x10800
  s_add_u32 s10, s14, 0x12000
  buffer_load_dwordx4 v16, s[52:55], s10 offen lds
  s_add_u32 m0, s9, 0x10c00
  s_add_u32 s10, s14, 0x16000
  buffer_load_dwordx4 v16, s[52:55], s10 offen lds
  s_add_u32 m0, s9, 0x14000
  s_add_u32 s10, s14, 0x10040
  buffer_load_dwordx4 v16, s[52:55], s10 offen lds
  s_add_u32 m0, s9, 0x14400
  s_add_u32 s10, s14, 0x14040
  buffer_load_dwordx4 v16, s[52:55], s10 offen lds
  s_add_u32 m0, s9, 0x14800
  s_add_u32 s10, s14, 0x12040
  buffer_load_dwordx4 v16, s[52:55], s10 offen lds
  s_add_u32 m0, s9, 0x14c00
  s_add_u32 s10, s14, 0x16040
  buffer_load_dwordx4 v16, s[52:55], s10 offen lds
  s_add_u32 m0, s9, 0x18000
  s_add_u32 s10, s14, 0x10080
  buffer_load_dwordx4 v16, s[52:55], s10 offen lds
  s_add_u32 m0, s9, 0x18400
  s_add_u32 s10, s14, 0x14080
  buffer_load_dwordx4 v16, s[52:55], s10 offen lds
  s_add_u32 m0, s9, 0x18800
  s_add_u32 s10, s14, 0x12080
  buffer_load_dwordx4 v16, s[52:55], s10 offen lds
  s_add_u32 m0, s9, 0x18c00
  s_add_u32 s10, s14, 0x16080
  buffer_load_dwordx4 v16, s[52:55], s10 offen lds
  s_add_u32 m0, s9, 0x1c000
  s_add_u32 s10, s14, 0x100c0
  buffer_load_dwordx4 v16, s[52:55], s10 offen lds
  s_add_u32 m0, s9, 0x1c400
  s_add_u32 s10, s14, 0x140c0
  buffer_load_dwordx4 v16, s[52:55], s10 offen lds
  s_add_u32 m0, s9, 0x1c800
  s_add_u32 s10, s14, 0x120c0
  buffer_load_dwordx4 v16, s[52:55], s10 offen lds
  s_add_u32 m0, s9, 0x1cc00
  s_add_u32 s10, s14, 0x160c0
  buffer_load_dwordx4 v16, s[52:55], s10 offen lds
  s_add_u32 m0, s9, 0x20000
  s_add_u32 s10, s16, 0x80
  buffer_load_dwordx4 v16, s[60:63], s10 offen lds
  s_add_u32 m0, s9, 0x20400
  s_add_u32 s10, s16, 0x4080
  buffer_load_dwordx4 v16, s[60:63], s10 offen lds
  s_add_u32 m0, s9, 0x20800
  s_add_u32 s10, s16, 0x2080
  buffer_load_dwordx4 v16, s[60:63], s10 offen lds
  s_add_u32 m0, s9, 0x20c00
  s_add_u32 s10, s16, 0x6080
  s_cmp_ge_u32 s4, 2
  s_cselect_b32 s10, 0x40000000, s10
  buffer_load_dwordx4 v16, s[60:63], s10 offen lds
  s_add_u32 m0, s9, 0x24000
  s_add_u32 s10, s16, 0xc0
  buffer_load_dwordx4 v16, s[60:63], s10 offen lds
  s_add_u32 m0, s9, 0x24400
  s_add_u32 s10, s16, 0x40c0
  buffer_load_dwordx4 v16, s[60:63], s10 offen lds
  s_add_u32 m0, s9, 0x24800
  s_add_u32 s10, s16, 0x20c0
  buffer_load_dwordx4 v16, s[60:63], s10 offen lds
  s_add_u32 m0, s9, 0x24c00
  s_add_u32 s10, s16, 0x60c0
  s_cmp_ge_u32 s4, 2
  s_cselect_b32 s10, 0x40000000, s10
  buffer_load_dwordx4 v16, s[60:63], s10 offen lds
  s_waitcnt vmcnt(0)
  s_barrier
  ds_read_b64_tr_b16 a[128:129], v10 offset:0
  ds_read_b64_tr_b16 a[130:131], v10 offset:1024
  ds_read_b64_tr_b16 a[132:133], v10 offset:8192
  ds_read_b64_tr_b16 a[134:135], v10 offset:9216
  ds_read_b64_tr_b16 a[136:137], v11 offset:0
  ds_read_b64_tr_b16 a[138:139], v11 offset:1024
  ds_read_b64_tr_b16 a[140:141], v11 offset:8192
  ds_read_b64_tr_b16 a[142:143], v11 offset:9216
  ds_read_b64_tr_b16 a[144:145], v10 offset:16384
  ds_read_b64_tr_b16 a[146:147], v10 offset:17408
  ds_read_b64_tr_b16 a[148:149], v10 offset:24576
  ds_read_b64_tr_b16 a[150:151], v10 offset:25600
  ds_read_b64_tr_b16 a[152:153], v11 offset:16384
  ds_read_b64_tr_b16 a[154:155], v11 offset:17408
  ds_read_b64_tr_b16 a[156:157], v11 offset:24576
  ds_read_b64_tr_b16 a[158:159], v11 offset:25600
  ds_read_b64_tr_b16 a[160:161], v10 offset:32768
  ds_read_b64_tr_b16 a[162:163], v10 offset:33792
  ds_read_b64_tr_b16 a[164:165], v10 offset:40960
  ds_read_b64_tr_b16 a[166:167], v10 offset:41984
  ds_read_b64_tr_b16 a[168:169], v11 offset:32768
  ds_read_b64_tr_b16 a[170:171], v11 offset:33792
  ds_read_b64_tr_b16 a[172:173], v11 offset:40960
  ds_read_b64_tr_b16 a[174:175], v11 offset:41984
  ds_read_b64_tr_b16 a[176:177], v10 offset:49152
  ds_read_b64_tr_b16 a[178:179], v10 offset:50176
  ds_read_b64_tr_b16 a[180:181], v10 offset:57344
  ds_read_b64_tr_b16 a[182:183], v10 offset:58368
  ds_read_b64_tr_b16 a[184:185], v11 offset:49152
  ds_read_b64_tr_b16 a[186:187], v11 offset:50176
  ds_read_b64_tr_b16 a[188:189], v11 offset:57344
  ds_read_b64_tr_b16 a[190:191], v11 offset:58368
  ds_read_b64_tr_b16 a[192:193], v12 offset:0
  ds_read_b64_tr_b16 a[194:195], v12 offset:1024
  ds_read_b64_tr_b16 a[196:197], v12 offset:8192
  ds_read_b64_tr_b16 a[198:199], v12 offset:9216
  ds_read_b64_tr_b16 a[200:201], v13 offset:0
  ds_read_b64_tr_b16 a[202:203], v13 offset:1024
  ds_read_b64_tr_b16 a[204:205], v13 offset:8192
  ds_read_b64_tr_b16 a[206:207], v13 offset:9216
  ds_read_b64_tr_b16 a[208:209], v12 offset:16384
  ds_read_b64_tr_b16 a[210:211], v12 offset:17408
  ds_read_b64_tr_b16 a[212:213], v12 offset:24576
  ds_read_b64_tr_b16 a[214:215], v12 offset:25600
  ds_read_b64_tr_b16 a[216:217], v13 offset:16384
  ds_read_b64_tr_b16 a[218:219], v13 offset:17408
  ds_read_b64_tr_b16 a[220:221], v13 offset:24576
  ds_read_b64_tr_b16 a[222:223], v13 offset:25600
  ds_read_b64_tr_b16 a[224:225], v12 offset:32768
  ds_read_b64_tr_b16 a[226:227], v12 offset:33792
  ds_read_b64_tr_b16 a[228:229], v12 offset:40960
  ds_read_b64_tr_b16 a[230:231], v12 offset:41984
  ds_read_b64_tr_b16 a[232:233], v13 offset:32768
  ds_read_b64_tr_b16 a[234:235], v13 offset:33792
  ds_read_b64_tr_b16 a[236:237], v13 offset:40960
  ds_read_b64_tr_b16 a[238:239], v13 offset:41984
  ds_read_b64_tr_b16 a[240:241], v12 offset:49152
  ds_read_b64_tr_b16 a[242:243], v12 offset:50176
  ds_read_b64_tr_b16 a[244:245], v12 offset:57344
  ds_read_b64_tr_b16 a[246:247], v12 offset:58368
  ds_read_b64_tr_b16 a[248:249], v13 offset:49152
  ds_read_b64_tr_b16 a[250:251], v13 offset:50176
  ds_read_b64_tr_b16 a[252:253], v13 offset:57344
  ds_read_b64_tr_b16 a[254:255], v13 offset:58368
  ds_read_b64_tr_b16 v[224:225], v14 offset:0
  ds_read_b64_tr_b16 v[226:227], v14 offset:1024
  ds_read_b64_tr_b16 v[228:229], v14 offset:8192
  ds_read_b64_tr_b16 v[230:231], v14 offset:9216
  ds_read_b64_tr_b16 v[232:233], v15 offset:0
  ds_read_b64_tr_b16 v[234:235], v15 offset:1024
  ds_read_b64_tr_b16 v[236:237], v15 offset:8192
  ds_read_b64_tr_b16 v[238:239], v15 offset:9216
  ds_read_b64_tr_b16 v[240:241], v14 offset:16384
  ds_read_b64_tr_b16 v[242:243], v14 offset:17408
  ds_read_b64_tr_b16 v[244:245], v14 offset:24576
  ds_read_b64_tr_b16 v[246:247], v14 offset:25600
  ds_read_b64_tr_b16 v[248:249], v15 offset:16384
  ds_read_b64_tr_b16 v[250:251], v15 offset:17408
  ds_read_b64_tr_b16 v[252:253], v15 offset:24576
  ds_read_b64_tr_b16 v[254:255], v15 offset:25600
  s_waitcnt lgkmcnt(0)
  s_barrier
  s_add_u32 m0, s9, 0x0
  s_add_u32 s10, s17, 0x0
  buffer_load_dwordx4 v17, s[56:59], s10 offen lds
  s_add_u32 m0, s9, 0x400
  s_add_u32 s10, s17, 0x3800
  buffer_load_dwordx4 v17, s[56:59], s10 offen lds
  s_add_u32 m0, s9, 0x800
  s_add_u32 s10, s17, 0xe000
  buffer_load_dwordx4 v17, s[56:59], s10 offen lds
  s_add_u32 m0, s9, 0xc00
  s_add_u32 s10, s17, 0x11800
  buffer_load_dwordx4 v17, s[56:59], s10 offen lds
  s_add_u32 m0, s9, 0x4000
  s_add_u32 s10, s17, 0x70000
  buffer_load_dwordx4 v17, s[56:59], s10 offen lds
  s_add_u32 m0, s9, 0x4400
  s_add_u32 s10, s17, 0x73800
  buffer_load_dwordx4 v17, s[56:59], s10 offen lds
  s_add_u32 m0, s9, 0x4800
  s_add_u32 s10, s17, 0x7e000
  buffer_load_dwordx4 v17, s[56:59], s10 offen lds
  s_add_u32 m0, s9, 0x4c00
  s_add_u32 s10, s17, 0x81800
  buffer_load_dwordx4 v17, s[56:59], s10 offen lds
  s_add_u32 m0, s9, 0x8000
  s_add_u32 s10, s17, 0xe0000
  buffer_load_dwordx4 v17, s[56:59], s10 offen lds
  s_add_u32 m0, s9, 0x8400
  s_add_u32 s10, s17, 0xe3800
  buffer_load_dwordx4 v17, s[56:59], s10 offen lds
  s_add_u32 m0, s9, 0x8800
  s_add_u32 s10, s17, 0xee000
  buffer_load_dwordx4 v17, s[56:59], s10 offen lds
  s_add_u32 m0, s9, 0x8c00
  s_add_u32 s10, s17, 0xf1800
  buffer_load_dwordx4 v17, s[56:59], s10 offen lds
  s_add_u32 m0, s9, 0xc000
  s_add_u32 s10, s17, 0x150000
  buffer_load_dwordx4 v17, s[56:59], s10 offen lds
  s_add_u32 m0, s9, 0xc400
  s_add_u32 s10, s17, 0x153800
  buffer_load_dwordx4 v17, s[56:59], s10 offen lds
  s_add_u32 m0, s9, 0xc800
  s_add_u32 s10, s17, 0x15e000
  buffer_load_dwordx4 v17, s[56:59], s10 offen lds
  s_add_u32 m0, s9, 0xcc00
  s_add_u32 s10, s17, 0x161800
  buffer_load_dwordx4 v17, s[56:59], s10 offen lds
  s_waitcnt vmcnt(0)
  s_barrier
  v_and_b32 v18, 0xc0, v0
  v_lshrrev_b32 v18, 1, v18
  v_and_b32 v19, 0x18, v0
  v_lshlrev_b32 v19, 2, v19
  v_xor_b32 v18, v18, v19
  v_and_b32 v19, 0x3, v0
  v_lshlrev_b32 v19, 3, v19
  v_xor_b32 v18, v18, v19
  v_and_b32 v19, 0x1c, v0
  v_lshlrev_b32 v19, 5, v19
  v_xor_b32 v18, v18, v19
  v_and_b32 v19, 0x20, v0
  v_lshlrev_b32 v19, 6, v19
  v_xor_b32 v18, v18, v19
  ds_read_b64_tr_b16 v[128:129], v18 offset:0
  ds_read_b64_tr_b16 v[130:131], v18 offset:1024
  ds_read_b64_tr_b16 v[132:133], v18 offset:4096
  ds_read_b64_tr_b16 v[134:135], v18 offset:5120
  ds_read_b64_tr_b16 v[136:137], v18 offset:8192
  ds_read_b64_tr_b16 v[138:139], v18 offset:9216
  ds_read_b64_tr_b16 v[140:141], v18 offset:12288
  ds_read_b64_tr_b16 v[142:143], v18 offset:13312
  ds_read_b64_tr_b16 v[144:145], v18 offset:16384
  ds_read_b64_tr_b16 v[146:147], v18 offset:17408
  ds_read_b64_tr_b16 v[148:149], v18 offset:20480
  ds_read_b64_tr_b16 v[150:151], v18 offset:21504
  ds_read_b64_tr_b16 v[152:153], v18 offset:24576
  ds_read_b64_tr_b16 v[154:155], v18 offset:25600
  ds_read_b64_tr_b16 v[156:157], v18 offset:28672
  ds_read_b64_tr_b16 v[158:159], v18 offset:29696
  ds_read_b64_tr_b16 v[160:161], v18 offset:32768
  ds_read_b64_tr_b16 v[162:163], v18 offset:33792
  ds_read_b64_tr_b16 v[164:165], v18 offset:36864
  ds_read_b64_tr_b16 v[166:167], v18 offset:37888
  ds_read_b64_tr_b16 v[168:169], v18 offset:40960
  ds_read_b64_tr_b16 v[170:171], v18 offset:41984
  ds_read_b64_tr_b16 v[172:173], v18 offset:45056
  ds_read_b64_tr_b16 v[174:175], v18 offset:46080
  ds_read_b64_tr_b16 v[176:177], v18 offset:49152
  ds_read_b64_tr_b16 v[178:179], v18 offset:50176
  ds_read_b64_tr_b16 v[180:181], v18 offset:53248
  ds_read_b64_tr_b16 v[182:183], v18 offset:54272
  ds_read_b64_tr_b16 v[184:185], v18 offset:57344
  ds_read_b64_tr_b16 v[186:187], v18 offset:58368
  ds_read_b64_tr_b16 v[188:189], v18 offset:61440
  ds_read_b64_tr_b16 v[190:191], v18 offset:62464
  s_waitcnt lgkmcnt(0)
  s_barrier
  s_mov_b32 s14, 0
L_rdy_12:
  buffer_load_dword v4, off, s[68:71], 0 offset:128 sc1
  s_add_u32 s14, s14, 1
  s_cmp_gt_u32 s14, 200000
  s_cbranch_scc1 L_end
  s_waitcnt vmcnt(0)
  v_readfirstlane_b32 s10, v4
  s_nop 0
  s_cmp_eq_u32 s10, 0
  s_cbranch_scc1 L_rdy_12
  s_cmp_lg_u32 s10, s95
  s_cbranch_scc1 L_restart
  v_lshlrev_b32 v3, 3, v2
  s_mov_b32 s14, 0
L_lnp_13:
  buffer_load_dwordx2 v[4:5], v3, s[72:75], 0 offen offset:0 sc1
  s_add_u32 s14, s14, 1
  s_cmp_gt_u32 s14, 200000
  s_cbranch_scc1 L_end
  s_waitcnt vmcnt(0)
  v_and_b32 v4, v4, v5
  v_cmp_ne_u32 vcc, 1, v4
  s_cbranch_vccnz L_lnp_13
  s_mov_b32 s11, 0x3f80
  v_mov_b32 v18, 0x3f803f80
  v_and_b32 v16, 3, v2
  v_bfe_u32 v17, v2, 2, 2
  v_lshlrev_b32 v4, 4, v16
  v_lshlrev_b32 v4, v4, s11
  v_cmp_eq_u32 vcc, 0, v17
  s_nop 1
  v_cndmask_b32 v4, 0, v4, vcc
  v_cmp_gt_u32 vcc, 2, v16
  s_nop 1
  v_cndmask_b32 v4, 0, v4, vcc
  v_cmp_eq_u32 vcc, 2, v16
  s_nop 1
  v_cndmask_b32 v4, v4, v18, vcc
  v_lshlrev_b32 v5, 4, v16
  v_lshlrev_b32 v5, v5, s11
  v_cmp_eq_u32 vcc, 1, v17
  s_nop 1
  v_cndmask_b32 v5, 0, v5, vcc
  v_cmp_gt_u32 vcc, 2, v16
  s_nop 1
  v_cndmask_b32 v5, 0, v5, vcc
  v_cmp_eq_u32 vcc, 2, v16
  s_nop 1
  v_cndmask_b32 v5, v5, v18, vcc
  v_lshlrev_b32 v6, 4, v16
  v_lshlrev_b32 v6, v6, s11
  v_cmp_eq_u32 vcc, 2, v17
  s_nop 1
  v_cndmask_b32 v6, 0, v6, vcc
  v_cmp_gt_u32 vcc, 2, v16
  s_nop 1
  v_cndmask_b32 v6, 0, v6, vcc
  v_cmp_eq_u32 vcc, 2, v16
  s_nop 1
  v_cndmask_b32 v6, v6, v18, vcc
  v_lshlrev_b32 v7, 4, v16
  v_lshlrev_b32 v7, v7, s11
  v_cmp_eq_u32 vcc, 3, v17
  s_nop 1
  v_cndmask_b32 v7, 0, v7, vcc
  v_cmp_gt_u32 vcc, 2, v16
  s_nop 1
  v_cndmask_b32 v7, 0, v7, vcc
  v_cmp_eq_u32 vcc, 2, v16
  s_nop 1
  v_cndmask_b32 v7, v7, v18, vcc
  v_mov_b32 v12, v4
  v_mov_b32 v13, 0
  v_and_b32 v3, 0x30, v0
  v_and_b32 v16, 0xc, v0
  v_lshlrev_b32 v16, 7, v16
  v_xor_b32 v3, v3, v16
  v_and_b32 v16, 0x1, v0
  v_lshlrev_b32 v16, 8, v16
  v_xor_b32 v3, v3, v16
  v_and_b32 v8, 0xc0, v0
  v_lshlrev_b32 v8, 2, v8
  v_and_b32 v16, 0xf, v0
  v_lshlrev_b32 v16, 4, v16
  v_xor_b32 v8, v8, v16
  v_and_b32 v16, 0x30, v0
  v_lshlrev_b32 v16, 13, v16
  v_xor_b32 v8, v8, v16
  s_mov_b32 s36, 0xaaaaaaaa
  s_mov_b32 s37, 0xaaaaaaaa
  v_and_b32 v9, 0xc0, v0
  v_lshlrev_b32 v9, 2, v9
  v_and_b32 v16, 0xf, v0
  v_lshlrev_b32 v16, 4, v16
  v_xor_b32 v9, v9, v16
  v_and_b32 v16, 0x30, v0
  v_lshlrev_b32 v16, 6, v16
  v_xor_b32 v9, v9, v16
  v_and_b32 v10, 0xe, v0
  v_lshlrev_b32 v10, 1, v10
  v_and_b32 v16, 0xf0, v0
  v_lshlrev_b32 v16, 2, v16
  v_xor_b32 v10, v10, v16
  v_and_b32 v16, 0x1, v0
  v_lshlrev_b32 v16, 5, v16
  v_xor_b32 v10, v10, v16
  s_and_b32 s24, s4, 1
  s_lshr_b32 s25, s4, 1
  s_lshl_b32 s10, s24, 4
  v_and_b32 v16, 15, v2
  v_add_u32 v16, s10, v16
  v_bfe_u32 v17, v2, 4, 2
  v_lshlrev_b32 v17, 2, v17
  v_sub_u32 v16, v16, v17
  v_cmp_le_i32 s[80:81], 0, v16
  v_cmp_le_i32 s[82:83], 1, v16
  v_cmp_le_i32 s[84:85], 2, v16
  v_cmp_le_i32 s[86:87], 3, v16
  v_cmp_le_i32 s[88:89], 16, v16
  v_cmp_le_i32 s[90:91], 17, v16
  v_cmp_le_i32 s[92:93], 18, v16
  v_cmp_le_i32 s[94:95], 19, v16
  v_mov_b32 v2, v1
  s_mov_b32 s19, 0
  s_lshl_b32 s15, s6, 15
  s_lshl_b32 s10, s4, 13
  s_add_u32 s15, s15, s10
  s_add_u32 s15, s15, 0x100000
  s_mov_b32 s18, s10
  s_lshl_b32 s20, s6, 5
  s_add_u32 s20, s20, s5
  s_lshl_b32 s21, s20, 13
  s_add_u32 s21, s21, 0x2440000
  s_lshl_b32 s20, s20, 14
  s_add_u32 s20, s20, s9
  s_add_u32 s20, s20, 0x400000
  s_add_u32 s22, s9, 32768
  s_lshl_b32 s26, s5, 7
  s_add_u32 s26, s26, 0x2000
  s_mov_b32 s27, s6
  s_mov_b32 s23, 0x3e0293ee
  s_lshl_b32 s76, s5, 8
  s_add_u32 s76, s76, 0x3000
  s_lshl_b32 s77, s4, 13
  s_add_u32 s77, s77, 0x20000
  s_mov_b32 s28, 0xceabfb8f
  s_lshl_b32 s29, s24, 12
  s_add_u32 s29, s29, 0x18000
  s_lshl_b32 s30, s4, 10
  s_add_u32 s30, s30, 0x18000
  s_lshl_b32 s31, s25, 10
  s_lshl_b32 s10, s24, 3
  s_add_u32 s31, s31, s10
  s_add_u32 s31, s31, 0x1a000
  s_and_b32 s10, s27, 1
  s_lshl_b32 s10, s10, 7
  s_add_u32 s78, s10, s76
  buffer_load_dword v16, off, s[72:75], s78 sc1
  s_add_u32 m0, s18, 0
  s_add_u32 s10, s15, 0
  buffer_load_dwordx4 v1, s[72:75], s10 offen offset:0 sc1 lds
  buffer_load_dwordx4 v1, s[72:75], s10 offen offset:1024 sc1 lds
  buffer_load_dwordx4 v1, s[72:75], s10 offen offset:2048 sc1 lds
  buffer_load_dwordx4 v1, s[72:75], s10 offen offset:3072 sc1 lds
  s_add_u32 m0, s18, 4096
  s_add_u32 s10, s15, 4096
  buffer_load_dwordx4 v1, s[72:75], s10 offen offset:0 sc1 lds
  buffer_load_dwordx4 v1, s[72:75], s10 offen offset:1024 sc1 lds
  buffer_load_dwordx4 v1, s[72:75], s10 offen offset:2048 sc1 lds
  buffer_load_dwordx4 v1, s[72:75], s10 offen offset:3072 sc1 lds
  s_waitcnt vmcnt(8)
  s_mov_b32 s14, 0
  s_lshr_b32 s11, s27, 1
L_kv_14:
  v_readfirstlane_b32 s10, v16
  s_nop 0
  s_cmp_gt_u32 s10, s11
  s_cbranch_scc1 L_kv_14k
  s_sleep 8
  buffer_load_dword v16, off, s[72:75], s78 sc1
  s_add_u32 s14, s14, 1
  s_cmp_gt_u32 s14, 200000
  s_cbranch_scc1 L_end
  s_waitcnt vmcnt(0)
  s_branch L_kv_14
L_kv_14k:
  s_mov_b32 m0, s22
  s_nop 0
  buffer_load_dwordx4 v1, s[72:75], s20 offen offset:0 sc1 lds
  buffer_load_dwordx4 v1, s[72:75], s20 offen offset:1024 sc1 lds
  buffer_load_dwordx4 v1, s[72:75], s20 offen offset:2048 sc1 lds
  buffer_load_dwordx4 v1, s[72:75], s20 offen offset:3072 sc1 lds
  s_mov_b32 s7, s6
  s_mov_b32 s8, 1
  s_lshl_b32 s10, s7, 5
  s_add_u32 s10, s10, s5
  s_lshl_b32 s16, s10, 10
  s_and_b32 s17, s8, 3
  s_lshl_b32 s10, s6, 2
  s_add_u32 s17, s17, s10
  s_lshl_b32 s17, s17, 5
  s_add_u32 s17, s17, s5
  s_lshl_b32 s17, s17, 15
  s_add_u32 s17, s17, 0x3500000
  s_lshl_b32 s79, s7, 7
  s_add_u32 s79, s79, 0x6000
  s_waitcnt vmcnt(0)
  s_barrier
L_C:
  s_and_b32 s13, s27, 1
  s_lshl_b32 s13, s13, 4
  s_cmp_ge_u32 s27, 62
  s_cselect_b32 s10, 64, 0
  s_add_u32 s13, s13, s10
  s_add_u32 s13, s13, s26
  s_mov_b64 exec, 15
  v_lshrrev_b32 v18, 2, v1
  buffer_load_dword v18, v18, s[72:75], s13 offen sc1
  s_mov_b64 exec, -1
  buffer_load_dword v17, off, s[72:75], s79 sc1
  s_add_u32 s19, s19, 1
  s_cmp_ge_u32 s19, s12
  s_cbranch_scc1 L_C_nd
  s_add_u32 s15, s15, 131072
  s_add_u32 s20, s20, 2097152
  s_add_u32 s10, s18, 49152
  s_sub_u32 s11, s18, 49152
  s_cselect_b32 s18, s10, s11
  s_add_u32 s10, s22, 49152
  s_sub_u32 s11, s22, 49152
  s_cselect_b32 s22, s10, s11
  s_add_u32 s11, s27, 4
  s_and_b32 s10, s11, 1
  s_lshl_b32 s10, s10, 7
  s_add_u32 s78, s10, s76
  buffer_load_dword v16, off, s[72:75], s78 sc1
  s_add_u32 m0, s18, 0
  s_add_u32 s10, s15, 0
  buffer_load_dwordx4 v1, s[72:75], s10 offen offset:0 sc1 lds
  buffer_load_dwordx4 v1, s[72:75], s10 offen offset:1024 sc1 lds
  buffer_load_dwordx4 v1, s[72:75], s10 offen offset:2048 sc1 lds
  buffer_load_dwordx4 v1, s[72:75], s10 offen offset:3072 sc1 lds
  s_add_u32 m0, s18, 4096
  s_add_u32 s10, s15, 4096
  buffer_load_dwordx4 v1, s[72:75], s10 offen offset:0 sc1 lds
  buffer_load_dwordx4 v1, s[72:75], s10 offen offset:1024 sc1 lds
  buffer_load_dwordx4 v1, s[72:75], s10 offen offset:2048 sc1 lds
  buffer_load_dwordx4 v1, s[72:75], s10 offen offset:3072 sc1 lds
L_C_nd:
  ds_read_b128 v[20:23], v2 offset:0
  ds_read_b128 v[24:27], v2 offset:16384
  ds_read_b128 v[28:31], v2 offset:1024
  ds_read_b128 v[32:35], v2 offset:17408
  ds_read_b128 v[36:39], v2 offset:2048
  ds_read_b128 v[40:43], v2 offset:18432
  ds_read_b128 v[44:47], v2 offset:3072
  ds_read_b128 v[48:51], v2 offset:19456
  s_waitcnt lgkmcnt(6)
  v_mfma_f32_16x16x32_bf16 v[52:55], a[0:3], v[20:23], 0
  v_mfma_f32_16x16x32_bf16 v[56:59], a[8:11], v[20:23], 0
  v_mfma_f32_16x16x32_bf16 v[68:71], v[128:131], v[20:23], 0
  v_mfma_f32_16x16x32_bf16 v[60:63], a[0:3], v[24:27], 0
  v_mfma_f32_16x16x32_bf16 v[64:67], a[8:11], v[24:27], 0
  v_mfma_f32_16x16x32_bf16 v[72:75], v[128:131], v[24:27], 0
  ds_read_b128 v[20:23], v2 offset:4096
  ds_read_b128 v[24:27], v2 offset:20480
  s_waitcnt lgkmcnt(6)
  v_mfma_f32_16x16x32_bf16 v[52:55], a[4:7], v[28:31], v[52:55]
  v_mfma_f32_16x16x32_bf16 v[56:59], a[12:15], v[28:31], v[56:59]
  v_mfma_f32_16x16x32_bf16 v[68:71], v[132:135], v[28:31], v[68:71]
  v_mfma_f32_16x16x32_bf16 v[60:63], a[4:7], v[32:35], v[60:63]
  v_mfma_f32_16x16x32_bf16 v[64:67], a[12:15], v[32:35], v[64:67]
  v_mfma_f32_16x16x32_bf16 v[72:75], v[132:135], v[32:35], v[72:75]
  ds_read_b128 v[28:31], v2 offset:5120
  ds_read_b128 v[32:35], v2 offset:21504
  s_waitcnt lgkmcnt(6)
  v_mfma_f32_16x16x32_bf16 v[52:55], a[16:19], v[36:39], v[52:55]
  v_mfma_f32_16x16x32_bf16 v[56:59], a[24:27], v[36:39], v[56:59]
  v_mfma_f32_16x16x32_bf16 v[68:71], v[136:139], v[36:39], v[68:71]
  v_mfma_f32_16x16x32_bf16 v[60:63], a[16:19], v[40:43], v[60:63]
  v_mfma_f32_16x16x32_bf16 v[64:67], a[24:27], v[40:43], v[64:67]
  v_mfma_f32_16x16x32_bf16 v[72:75], v[136:139], v[40:43], v[72:75]
  ds_read_b128 v[36:39], v2 offset:6144
  ds_read_b128 v[40:43], v2 offset:22528
  s_waitcnt lgkmcnt(6)
  v_mfma_f32_16x16x32_bf16 v[52:55], a[20:23], v[44:47], v[52:55]
  v_mfma_f32_16x16x32_bf16 v[56:59], a[28:31], v[44:47], v[56:59]
  v_mfma_f32_16x16x32_bf16 v[68:71], v[140:143], v[44:47], v[68:71]
  v_mfma_f32_16x16x32_bf16 v[60:63], a[20:23], v[48:51], v[60:63]
  v_mfma_f32_16x16x32_bf16 v[64:67], a[28:31], v[48:51], v[64:67]
  v_mfma_f32_16x16x32_bf16 v[72:75], v[140:143], v[48:51], v[72:75]
  ds_read_b128 v[44:47], v2 offset:7168
  ds_read_b128 v[48:51], v2 offset:23552
  s_waitcnt lgkmcnt(6)
  v_mfma_f32_16x16x32_bf16 v[52:55], a[32:35], v[20:23], v[52:55]
  v_mfma_f32_16x16x32_bf16 v[56:59], a[40:43], v[20:23], v[56:59]
  v_mfma_f32_16x16x32_bf16 v[68:71], v[144:147], v[20:23], v[68:71]
  v_mfma_f32_16x16x32_bf16 v[60:63], a[32:35], v[24:27], v[60:63]
  v_mfma_f32_16x16x32_bf16 v[64:67], a[40:43], v[24:27], v[64:67]
  v_mfma_f32_16x16x32_bf16 v[72:75], v[144:147], v[24:27], v[72:75]
  ds_read_b128 v[20:23], v2 offset:8192
  ds_read_b128 v[24:27], v2 offset:24576
  s_waitcnt lgkmcnt(6)
  v_mfma_f32_16x16x32_bf16 v[52:55], a[36:39], v[28:31], v[52:55]
  v_mfma_f32_16x16x32_bf16 v[56:59], a[44:47], v[28:31], v[56:59]
  v_mfma_f32_16x16x32_bf16 v[68:71], v[148:151], v[28:31], v[68:71]
  v_mfma_f32_16x16x32_bf16 v[60:63], a[36:39], v[32:35], v[60:63]
  v_mfma_f32_16x16x32_bf16 v[64:67], a[44:47], v[32:35], v[64:67]
  v_mfma_f32_16x16x32_bf16 v[72:75], v[148:151], v[32:35], v[72:75]
  ds_read_b128 v[28:31], v2 offset:9216
  ds_read_b128 v[32:35], v2 offset:25600
  s_waitcnt lgkmcnt(6)
  v_mfma_f32_16x16x32_bf16 v[52:55], a[48:51], v[36:39], v[52:55]
  v_mfma_f32_16x16x32_bf16 v[56:59], a[56:59], v[36:39], v[56:59]
  v_mfma_f32_16x16x32_bf16 v[68:71], v[152:155], v[36:39], v[68:71]
  v_mfma_f32_16x16x32_bf16 v[60:63], a[48:51], v[40:43], v[60:63]
  v_mfma_f32_16x16x32_bf16 v[64:67], a[56:59], v[40:43], v[64:67]
  v_mfma_f32_16x16x32_bf16 v[72:75], v[152:155], v[40:43], v[72:75]
  ds_read_b128 v[36:39], v2 offset:10240
  ds_read_b128 v[40:43], v2 offset:26624
  s_waitcnt lgkmcnt(6)
  v_mfma_f32_16x16x32_bf16 v[52:55], a[52:55], v[44:47], v[52:55]
  v_mfma_f32_16x16x32_bf16 v[56:59], a[60:63], v[44:47], v[56:59]
  v_mfma_f32_16x16x32_bf16 v[68:71], v[156:159], v[44:47], v[68:71]
  v_mfma_f32_16x16x32_bf16 v[60:63], a[52:55], v[48:51], v[60:63]
  v_mfma_f32_16x16x32_bf16 v[64:67], a[60:63], v[48:51], v[64:67]
  v_mfma_f32_16x16x32_bf16 v[72:75], v[156:159], v[48:51], v[72:75]
  ds_read_b128 v[44:47], v2 offset:11264
  ds_read_b128 v[48:51], v2 offset:27648
  s_waitcnt lgkmcnt(6)
  v_mfma_f32_16x16x32_bf16 v[52:55], a[64:67], v[20:23], v[52:55]
  v_mfma_f32_16x16x32_bf16 v[56:59], a[72:75], v[20:23], v[56:59]
  v_mfma_f32_16x16x32_bf16 v[68:71], v[160:163], v[20:23], v[68:71]
  v_mfma_f32_16x16x32_bf16 v[60:63], a[64:67], v[24:27], v[60:63]
  v_mfma_f32_16x16x32_bf16 v[64:67], a[72:75], v[24:27], v[64:67]
  v_mfma_f32_16x16x32_bf16 v[72:75], v[160:163], v[24:27], v[72:75]
  ds_read_b128 v[20:23], v2 offset:12288
  ds_read_b128 v[24:27], v2 offset:28672
  s_waitcnt lgkmcnt(6)
  v_mfma_f32_16x16x32_bf16 v[52:55], a[68:71], v[28:31], v[52:55]
  v_mfma_f32_16x16x32_bf16 v[56:59], a[76:79], v[28:31], v[56:59]
  v_mfma_f32_16x16x32_bf16 v[68:71], v[164:167], v[28:31], v[68:71]
  v_mfma_f32_16x16x32_bf16 v[60:63], a[68:71], v[32:35], v[60:63]
  v_mfma_f32_16x16x32_bf16 v[64:67], a[76:79], v[32:35], v[64:67]
  v_mfma_f32_16x16x32_bf16 v[72:75], v[164:167], v[32:35], v[72:75]
  ds_read_b128 v[28:31], v2 offset:13312
  ds_read_b128 v[32:35], v2 offset:29696
  s_waitcnt lgkmcnt(6)
  v_mfma_f32_16x16x32_bf16 v[52:55], a[80:83], v[36:39], v[52:55]
  v_mfma_f32_16x16x32_bf16 v[56:59], a[88:91], v[36:39], v[56:59]
  v_mfma_f32_16x16x32_bf16 v[68:71], v[168:171], v[36:39], v[68:71]
  v_mfma_f32_16x16x32_bf16 v[60:63], a[80:83], v[40:43], v[60:63]
  v_mfma_f32_16x16x32_bf16 v[64:67], a[88:91], v[40:43], v[64:67]
  v_mfma_f32_16x16x32_bf16 v[72:75], v[168:171], v[40:43], v[72:75]
  ds_read_b128 v[36:39], v2 offset:14336
  ds_read_b128 v[40:43], v2 offset:30720
  s_waitcnt lgkmcnt(6)
  v_mfma_f32_16x16x32_bf16 v[52:55], a[84:87], v[44:47], v[52:55]
  v_mfma_f32_16x16x32_bf16 v[56:59], a[92:95], v[44:47], v[56:59]
  v_mfma_f32_16x16x32_bf16 v[68:71], v[172:175], v[44:47], v[68:71]
  v_mfma_f32_16x16x32_bf16 v[60:63], a[84:87], v[48:51], v[60:63]
  v_mfma_f32_16x16x32_bf16 v[64:67], a[92:95], v[48:51], v[64:67]
  v_mfma_f32_16x16x32_bf16 v[72:75], v[172:175], v[48:51], v[72:75]
  ds_read_b128 v[44:47], v2 offset:15360
  ds_read_b128 v[48:51], v2 offset:31744
  s_waitcnt lgkmcnt(6)
  v_mfma_f32_16x16x32_bf16 v[52:55], a[96:99], v[20:23], v[52:55]
  v_mfma_f32_16x16x32_bf16 v[56:59], a[104:107], v[20:23], v[56:59]
  v_mfma_f32_16x16x32_bf16 v[68:71], v[176:179], v[20:23], v[68:71]
  v_mfma_f32_16x16x32_bf16 v[60:63], a[96:99], v[24:27], v[60:63]
  v_mfma_f32_16x16x32_bf16 v[64:67], a[104:107], v[24:27], v[64:67]
  v_mfma_f32_16x16x32_bf16 v[72:75], v[176:179], v[24:27], v[72:75]
  s_waitcnt lgkmcnt(4)
  v_mfma_f32_16x16x32_bf16 v[52:55], a[100:103], v[28:31], v[52:55]
  v_mfma_f32_16x16x32_bf16 v[56:59], a[108:111], v[28:31], v[56:59]
  v_mfma_f32_16x16x32_bf16 v[68:71], v[180:183], v[28:31], v[68:71]
  v_mfma_f32_16x16x32_bf16 v[60:63], a[100:103], v[32:35], v[60:63]
  v_mfma_f32_16x16x32_bf16 v[64:67], a[108:111], v[32:35], v[64:67]
  v_mfma_f32_16x16x32_bf16 v[72:75], v[180:183], v[32:35], v[72:75]
  s_waitcnt lgkmcnt(2)
  v_mfma_f32_16x16x32_bf16 v[52:55], a[112:115], v[36:39], v[52:55]
  v_mfma_f32_16x16x32_bf16 v[56:59], a[120:123], v[36:39], v[56:59]
  v_mfma_f32_16x16x32_bf16 v[68:71], v[184:187], v[36:39], v[68:71]
  v_mfma_f32_16x16x32_bf16 v[60:63], a[112:115], v[40:43], v[60:63]
  v_mfma_f32_16x16x32_bf16 v[64:67], a[120:123], v[40:43], v[64:67]
  v_mfma_f32_16x16x32_bf16 v[72:75], v[184:187], v[40:43], v[72:75]
  s_waitcnt lgkmcnt(0)
  v_mfma_f32_16x16x32_bf16 v[52:55], a[116:119], v[44:47], v[52:55]
  v_mfma_f32_16x16x32_bf16 v[56:59], a[124:127], v[44:47], v[56:59]
  v_mfma_f32_16x16x32_bf16 v[68:71], v[188:191], v[44:47], v[68:71]
  v_mfma_f32_16x16x32_bf16 v[60:63], a[116:119], v[48:51], v[60:63]
  v_mfma_f32_16x16x32_bf16 v[64:67], a[124:127], v[48:51], v[64:67]
  v_mfma_f32_16x16x32_bf16 v[72:75], v[188:191], v[48:51], v[72:75]
  v_add_u32 v0, s30, v1
  v_add_u32 v11, s31, v1
  v_cvt_pk_bf16_f32 v20, v52, v56
  v_cvt_pk_bf16_f32 v21, v53, v57
  v_cvt_pk_bf16_f32 v22, v54, v58
  v_cvt_pk_bf16_f32 v23, v55, v59
  ds_write_b128 v0, v[20:23] offset:0
  v_cvt_pk_bf16_f32 v24, v60, v64
  v_cvt_pk_bf16_f32 v25, v61, v65
  v_cvt_pk_bf16_f32 v26, v62, v66
  v_cvt_pk_bf16_f32 v27, v63, v67
  ds_write_b128 v0, v[24:27] offset:4096
  v_max_f32 v68, 0, v68
  v_max_f32 v69, 0, v69
  v_max_f32 v70, 0, v70
  v_max_f32 v71, 0, v71
  v_cvt_pk_bf16_f32 v28, v68, v69
  v_cvt_pk_bf16_f32 v29, v70, v71
  ds_write_b64 v11, v[28:29] offset:0
  v_max_f32 v72, 0, v72
  v_max_f32 v73, 0, v73
  v_max_f32 v74, 0, v74
  v_max_f32 v75, 0, v75
  v_cvt_pk_bf16_f32 v30, v72, v73
  v_cvt_pk_bf16_f32 v31, v74, v75
  ds_write_b64 v11, v[30:31] offset:2048
  s_cmp_ge_u32 s19, s12
  s_cbranch_scc1 L_C_la
  s_waitcnt vmcnt(8)
  s_add_u32 s3, s27, 4
  s_mov_b32 s14, 0
  s_lshr_b32 s11, s3, 1
L_kv_15:
  v_readfirstlane_b32 s10, v16
  s_nop 0
  s_cmp_gt_u32 s10, s11
  s_cbranch_scc1 L_kv_15k
  s_sleep 8
  buffer_load_dword v16, off, s[72:75], s78 sc1
  s_add_u32 s14, s14, 1
  s_cmp_gt_u32 s14, 200000
  s_cbranch_scc1 L_end
  s_waitcnt vmcnt(0)
  s_branch L_kv_15
L_kv_15k:
  s_mov_b32 m0, s22
  s_nop 0
  buffer_load_dwordx4 v1, s[72:75], s20 offen offset:0 sc1 lds
  buffer_load_dwordx4 v1, s[72:75], s20 offen offset:1024 sc1 lds
  buffer_load_dwordx4 v1, s[72:75], s20 offen offset:2048 sc1 lds
  buffer_load_dwordx4 v1, s[72:75], s20 offen offset:3072 sc1 lds
  s_branch L_C_nk
L_C_la:
  s_waitcnt vmcnt(0)
L_C_nk:
  s_cmp_le_u32 s19, 2
  s_cbranch_scc1 L_C_nr
  s_mov_b32 s14, 0
L_rg_16:
  v_readfirstlane_b32 s10, v17
  s_nop 0
  s_cmp_ge_u32 s10, 32
  s_cbranch_scc1 L_rg_16k
  s_sleep 8
  buffer_load_dword v17, off, s[72:75], s79 sc1
  s_add_u32 s14, s14, 1
  s_cmp_gt_u32 s14, 200000
  s_cbranch_scc1 L_end
  s_waitcnt vmcnt(0)
  s_branch L_rg_16
L_rg_16k:
  buffer_load_dword v19, v10, s[32:35], s16 offen
  s_add_u32 m0, s77, 0
  s_nop 0
  buffer_load_dwordx4 v9, s[72:75], s17 offen sc1 lds
  s_add_u32 s17, s17, 4096
  s_add_u32 m0, s77, 1024
  s_nop 0
  buffer_load_dwordx4 v9, s[72:75], s17 offen sc1 lds
  s_add_u32 s17, s17, 4096
  s_add_u32 m0, s77, 2048
  s_nop 0
  buffer_load_dwordx4 v9, s[72:75], s17 offen sc1 lds
  s_add_u32 s17, s17, 4096
  s_add_u32 m0, s77, 3072
  s_nop 0
  buffer_load_dwordx4 v9, s[72:75], s17 offen sc1 lds
  s_add_u32 s17, s17, 4096
  s_add_u32 m0, s77, 4096
  s_nop 0
  buffer_load_dwordx4 v9, s[72:75], s17 offen sc1 lds
  s_add_u32 s17, s17, 4096
  s_add_u32 m0, s77, 5120
  s_nop 0
  buffer_load_dwordx4 v9, s[72:75], s17 offen sc1 lds
  s_add_u32 s17, s17, 4096
  s_add_u32 m0, s77, 6144
  s_nop 0
  buffer_load_dwordx4 v9, s[72:75], s17 offen sc1 lds
  s_add_u32 s17, s17, 4096
  s_add_u32 m0, s77, 7168
  s_nop 0
  buffer_load_dwordx4 v9, s[72:75], s17 offen sc1 lds
L_C_nr:
  v_add_u32 v0, s29, v1
  v_add_u32 v11, 0x18000, v1
  s_waitcnt lgkmcnt(0)
  s_barrier
  s_cmp_eq_u32 s19, 1
  s_cbranch_scc1 L_C_nh
  s_cmp_lg_u32 s4, 0
  s_cbranch_scc1 L_ho_17
  v_mov_b32 v16, 1
  s_sub_u32 s10, s27, 4
  s_lshl_b32 s10, s10, 7
  s_add_u32 s10, s10, 0x6000
  s_mov_b64 exec, 1
  buffer_atomic_add v16, off, s[72:75], s10 sc1
  s_mov_b64 exec, -1
L_ho_17:
L_C_nh:
  ds_read_b128 v[20:23], v0 offset:0
  ds_read_b128 v[24:27], v0 offset:1024
  ds_read_b128 v[28:31], v0 offset:2048
  ds_read_b128 v[32:35], v0 offset:3072
  ds_read_b128 v[52:55], v2 offset:32768
  ds_read_b128 v[56:59], v2 offset:33792
  ds_read_b128 v[60:63], v2 offset:34816
  ds_read_b128 v[64:67], v2 offset:35840
  ds_read_b128 v[68:71], v2 offset:36864
  ds_read_b128 v[72:75], v2 offset:37888
  ds_read_b128 v[76:79], v2 offset:38912
  ds_read_b128 v[80:83], v2 offset:39936
  ds_read_b128 v[36:39], v11 offset:8192
  ds_read_b128 v[40:43], v11 offset:9216
  ds_read_b128 v[44:47], v11 offset:10240
  ds_read_b128 v[48:51], v11 offset:11264
  s_waitcnt lgkmcnt(4)
  v_mfma_f32_16x16x32_bf16 v[116:119], v[52:55], v[20:23], 0
  v_mfma_f32_16x16x32_bf16 v[116:119], v[56:59], v[24:27], v[116:119]
  v_mfma_f32_16x16x32_bf16 v[116:119], v[60:63], v[28:31], v[116:119]
  v_mfma_f32_16x16x32_bf16 v[116:119], v[64:67], v[32:35], v[116:119]
  v_mfma_f32_16x16x32_bf16 v[120:123], v[68:71], v[20:23], 0
  v_mfma_f32_16x16x32_bf16 v[120:123], v[72:75], v[24:27], v[120:123]
  v_mfma_f32_16x16x32_bf16 v[120:123], v[76:79], v[28:31], v[120:123]
  v_mfma_f32_16x16x32_bf16 v[120:123], v[80:83], v[32:35], v[120:123]
  s_waitcnt lgkmcnt(0)
  v_mfma_f32_16x16x32_bf16 v[52:55], v[36:39], v[192:195], 0
  v_mfma_f32_16x16x32_bf16 v[84:87], v[44:47], v[192:195], 0
  v_mfma_f32_16x16x32_bf16 v[56:59], v[36:39], v[200:203], 0
  v_mfma_f32_16x16x32_bf16 v[88:91], v[44:47], v[200:203], 0
  v_mfma_f32_16x16x32_bf16 v[60:63], v[36:39], v[208:211], 0
  v_mfma_f32_16x16x32_bf16 v[92:95], v[44:47], v[208:211], 0
  v_mfma_f32_16x16x32_bf16 v[64:67], v[36:39], v[216:219], 0
  v_mfma_f32_16x16x32_bf16 v[96:99], v[44:47], v[216:219], 0
  v_mfma_f32_16x16x32_bf16 v[68:71], v[36:39], v[224:227], 0
  v_mfma_f32_16x16x32_bf16 v[100:103], v[44:47], v[224:227], 0
  v_mfma_f32_16x16x32_bf16 v[72:75], v[36:39], v[232:235], 0
  v_mfma_f32_16x16x32_bf16 v[104:107], v[44:47], v[232:235], 0
  v_mfma_f32_16x16x32_bf16 v[76:79], v[36:39], v[240:243], 0
  v_mfma_f32_16x16x32_bf16 v[108:111], v[44:47], v[240:243], 0
  v_mfma_f32_16x16x32_bf16 v[80:83], v[36:39], v[248:251], 0
  v_mfma_f32_16x16x32_bf16 v[112:115], v[44:47], v[248:251], 0
  v_mfma_f32_16x16x32_bf16 v[52:55], v[40:43], v[196:199], v[52:55]
  v_mfma_f32_16x16x32_bf16 v[84:87], v[48:51], v[196:199], v[84:87]
  v_mfma_f32_16x16x32_bf16 v[56:59], v[40:43], v[204:207], v[56:59]
  v_mfma_f32_16x16x32_bf16 v[88:91], v[48:51], v[204:207], v[88:91]
  v_mfma_f32_16x16x32_bf16 v[60:63], v[40:43], v[212:215], v[60:63]
  v_mfma_f32_16x16x32_bf16 v[92:95], v[48:51], v[212:215], v[92:95]
  v_mfma_f32_16x16x32_bf16 v[64:67], v[40:43], v[220:223], v[64:67]
  v_mfma_f32_16x16x32_bf16 v[96:99], v[48:51], v[220:223], v[96:99]
  v_mfma_f32_16x16x32_bf16 v[68:71], v[40:43], v[228:231], v[68:71]
  v_mfma_f32_16x16x32_bf16 v[100:103], v[48:51], v[228:231], v[100:103]
  v_mfma_f32_16x16x32_bf16 v[72:75], v[40:43], v[236:239], v[72:75]
  v_mfma_f32_16x16x32_bf16 v[104:107], v[48:51], v[236:239], v[104:107]
  v_mfma_f32_16x16x32_bf16 v[76:79], v[40:43], v[244:247], v[76:79]
  v_mfma_f32_16x16x32_bf16 v[108:111], v[48:51], v[244:247], v[108:111]
  v_mfma_f32_16x16x32_bf16 v[80:83], v[40:43], v[252:255], v[80:83]
  v_mfma_f32_16x16x32_bf16 v[112:115], v[48:51], v[252:255], v[112:115]
  v_mov_b32 v0, s28
  v_cndmask_b32 v116, v0, v116, s[80:81]
  v_cndmask_b32 v117, v0, v117, s[82:83]
  v_cndmask_b32 v118, v0, v118, s[84:85]
  v_cndmask_b32 v119, v0, v119, s[86:87]
  v_cndmask_b32 v120, v0, v120, s[88:89]
  v_cndmask_b32 v121, v0, v121, s[90:91]
  v_cndmask_b32 v122, v0, v122, s[92:93]
  v_cndmask_b32 v123, v0, v123, s[94:95]
  s_cmp_le_u32 s19, 2
  s_cbranch_scc1 L_C_nf
  v_add_u32 v0, s77, v1
  s_waitcnt vmcnt(0)
  ds_read_b128 v[36:39], v0 offset:0
  ds_read_b128 v[40:43], v0 offset:1024
  ds_read_b128 v[44:47], v0 offset:2048
  ds_read_b128 v[48:51], v0 offset:3072
  s_waitcnt lgkmcnt(3)
  v_mfma_f32_16x16x32_bf16 v[124:127], v[4:7], v[36:39], 0
  s_waitcnt lgkmcnt(2)
  v_mfma_f32_16x16x32_bf16 v[124:127], v[4:7], v[40:43], v[124:127]
  s_waitcnt lgkmcnt(1)
  v_mfma_f32_16x16x32_bf16 v[124:127], v[4:7], v[44:47], v[124:127]
  s_waitcnt lgkmcnt(0)
  v_mfma_f32_16x16x32_bf16 v[124:127], v[4:7], v[48:51], v[124:127]
  ds_read_b128 v[36:39], v0 offset:4096
  ds_read_b128 v[40:43], v0 offset:5120
  ds_read_b128 v[44:47], v0 offset:6144
  ds_read_b128 v[48:51], v0 offset:7168
  s_waitcnt lgkmcnt(3)
  v_mfma_f32_16x16x32_bf16 v[124:127], v[4:7], v[36:39], v[124:127]
  s_waitcnt lgkmcnt(2)
  v_mfma_f32_16x16x32_bf16 v[124:127], v[4:7], v[40:43], v[124:127]
  s_waitcnt lgkmcnt(1)
  v_mfma_f32_16x16x32_bf16 v[124:127], v[4:7], v[44:47], v[124:127]
  s_waitcnt lgkmcnt(0)
  v_mfma_f32_16x16x32_bf16 v[124:127], v[4:7], v[48:51], v[124:127]
  s_nop 7
  v_cndmask_b32_e64 v126, v125, v124, s[36:37]
  s_nop 1
  v_mov_b32_dpp v126, v126 quad_perm:[1,0,3,2] row_mask:0xf bank_mask:0xf
  v_cndmask_b32_e64 v124, v124, v126, s[36:37]
  v_cndmask_b32_e64 v125, v126, v125, s[36:37]
  v_lshlrev_b32 v0, 16, v19
  v_and_b32 v11, 0xffff0000, v19
  v_add_f32 v0, v0, v124
  v_add_f32 v11, v11, v125
  v_cvt_pk_bf16_f32 v0, v0, v11
  buffer_store_dword v0, v10, s[64:67], s16 offen
  s_add_u32 s7, s7, 4
  s_add_u32 s8, s8, 1
  s_lshl_b32 s10, s7, 5
  s_add_u32 s10, s10, s5
  s_lshl_b32 s16, s10, 10
  s_and_b32 s17, s8, 3
  s_lshl_b32 s10, s6, 2
  s_add_u32 s17, s17, s10
  s_lshl_b32 s17, s17, 5
  s_add_u32 s17, s17, s5
  s_lshl_b32 s17, s17, 15
  s_add_u32 s17, s17, 0x3500000
  s_lshl_b32 s79, s7, 7
  s_add_u32 s79, s79, 0x6000
L_C_nf:
  s_cmp_lg_u32 s19, 3
  s_cbranch_scc1 L_C_nm
  s_add_u32 s3, s6, 16
  v_mov_b64 v[36:37], -1
  v_mov_b64 v[38:39], -1
  s_lshl_b32 s10, s3, 20
  s_lshl_b32 s11, s5, 10
  s_add_u32 s10, s10, s11
  s_add_u32 s10, s10, 0x3500000
  s_add_u32 s11, s10, 524288
  s_add_u32 s11, s10, 0
  buffer_store_dwordx4 v[36:39], v8, s[72:75], s11 offen sc1
  s_add_u32 s11, s10, 524288
  buffer_store_dwordx4 v[36:39], v8, s[72:75], s11 offen sc1
  s_add_u32 s11, s10, 32768
  buffer_store_dwordx4 v[36:39], v8, s[72:75], s11 offen sc1
  s_add_u32 s11, s10, 557056
  buffer_store_dwordx4 v[36:39], v8, s[72:75], s11 offen sc1
  s_add_u32 s11, s10, 65536
  buffer_store_dwordx4 v[36:39], v8, s[72:75], s11 offen sc1
  s_add_u32 s11, s10, 589824
  buffer_store_dwordx4 v[36:39], v8, s[72:75], s11 offen sc1
  s_add_u32 s11, s10, 98304
  buffer_store_dwordx4 v[36:39], v8, s[72:75], s11 offen sc1
  s_add_u32 s11, s10, 622592
  buffer_store_dwordx4 v[36:39], v8, s[72:75], s11 offen sc1
L_C_nm:
  s_cmp_lt_u32 s27, 32
  s_cbranch_scc1 L_C_fl
  s_lshl_b32 s10, s4, 11
  s_add_u32 m0, s10, 0x1d000
  v_add_u32 v11, m0, v1
  s_lshl_b32 s10, s25, 11
  s_add_u32 s10, s10, s21
  s_add_u32 s10, s10, 2048
  s_cmp_ge_u32 s27, 62
  s_cselect_b32 s3, 0x40000, 0
  s_sub_u32 s3, s21, s3
  s_mov_b32 s14, 0
  s_mov_b64 exec, 15
  v_lshlrev_b32 v17, 6, v1
  s_branch L_C_dl1
L_C_dl:
  s_sleep 2
L_C_dl1:
  buffer_load_dword v16, v17, s[72:75], s3 offen offset:2048 sc1
  s_add_u32 s14, s14, 1
  s_cmp_gt_u32 s14, 200000
  s_cbranch_scc1 L_end
  s_waitcnt vmcnt(0)
  v_cmp_eq_u32 vcc, -1, v16
  s_cbranch_vccnz L_C_dl
  s_mov_b64 exec, -1
  s_mov_b32 s14, 0
  s_branch L_C_dp1
L_C_dp:
L_C_dp1:
  buffer_load_dwordx4 v[36:39], v3, s[72:75], s21 offen offset:0 sc1
  buffer_load_dwordx4 v[40:43], v3, s[72:75], s21 offen offset:64 sc1
  buffer_load_dwordx4 v[44:47], v3, s[72:75], s21 offen offset:128 sc1
  buffer_load_dwordx4 v[48:51], v3, s[72:75], s21 offen offset:192 sc1
  buffer_load_dwordx4 v[124:127], v1, s[72:75], s10 offen offset:0 sc1
  buffer_load_dwordx4 v[16:19], v1, s[72:75], s10 offen offset:1024 sc1
  s_add_u32 s14, s14, 1
  s_cmp_gt_u32 s14, 200000
  s_cbranch_scc1 L_end
  s_waitcnt vmcnt(2)
  v_max3_u32 v0, v36, v37, v38
  v_max3_u32 v0, v0, v39, v40
  v_max3_u32 v0, v0, v41, v42
  v_max3_u32 v0, v0, v43, v44
  v_max3_u32 v0, v0, v45, v46
  v_max3_u32 v0, v0, v47, v48
  v_max3_u32 v0, v0, v49, v50
  v_max_u32 v0, v0, v51
  v_cmp_eq_u32 vcc, -1, v0
  s_waitcnt vmcnt(0)
  v_max3_u32 v0, v0, v124, v125
  v_max3_u32 v0, v0, v126, v127
  v_max3_u32 v0, v0, v16, v17
  v_max3_u32 v0, v0, v18, v19
  v_cmp_eq_u32 vcc, -1, v0
  s_nop 0
  s_and_b64 exec, exec, vcc
  s_cbranch_scc1 L_C_dp
  s_mov_b64 exec, -1
  ds_write_b128 v11, v[124:127] offset:0
  ds_write_b128 v11, v[16:19] offset:1024
  s_branch L_C_go
L_C_fl:
  s_cmp_lg_u32 s4, 0
  s_cbranch_scc1 L_C_pw
  s_mov_b32 s14, 0
  s_lshr_b32 s3, s27, 1
L_C_pp:
  v_cmp_ge_u32 vcc, s3, v18
  s_nop 0
  s_and_b32 s10, vcc_lo, 15
  s_cbranch_scc0 L_C_pw
  s_cmp_ge_u32 s27, 60
  s_cbranch_scc1 L_C_p1
  s_sleep 24
L_C_p1:
  s_mov_b64 exec, 15
  v_lshrrev_b32 v18, 2, v1
  buffer_load_dword v18, v18, s[72:75], s13 offen sc1
  s_mov_b64 exec, -1
  s_add_u32 s14, s14, 1
  s_cmp_gt_u32 s14, 200000
  s_cbranch_scc1 L_end
  s_waitcnt vmcnt(0)
  s_branch L_C_pp
L_C_pw:
  s_barrier
  buffer_load_dwordx4 v[36:39], v3, s[72:75], s21 offen offset:0 sc1
  buffer_load_dwordx4 v[40:43], v3, s[72:75], s21 offen offset:64 sc1
  buffer_load_dwordx4 v[44:47], v3, s[72:75], s21 offen offset:128 sc1
  buffer_load_dwordx4 v[48:51], v3, s[72:75], s21 offen offset:192 sc1
  s_lshl_b32 s10, s4, 11
  s_add_u32 m0, s10, 0x1d000
  v_add_u32 v11, m0, v1
  s_lshl_b32 s10, s25, 11
  s_add_u32 s10, s10, s21
  s_add_u32 s10, s10, 2048
  buffer_load_dwordx4 v1, s[72:75], s10 offen sc1 lds
  buffer_load_dwordx4 v1, s[72:75], s10 offen offset:1024 sc1 lds
L_C_go:
  s_lshl_b32 s10, s25, 12
  v_add_u32 v0, s10, v2
  s_waitcnt vmcnt(5)
  v_mfma_f32_16x16x32_bf16 v[124:127], v[36:39], v[20:23], 0
  s_waitcnt vmcnt(4)
  v_mfma_f32_16x16x32_bf16 v[124:127], v[40:43], v[24:27], v[124:127]
  s_waitcnt vmcnt(3)
  v_mfma_f32_16x16x32_bf16 v[124:127], v[44:47], v[28:31], v[124:127]
  s_waitcnt vmcnt(2)
  v_mfma_f32_16x16x32_bf16 v[124:127], v[48:51], v[32:35], v[124:127]
  ds_read_b128 v[36:39], v0 offset:40960
  ds_read_b128 v[40:43], v0 offset:41984
  ds_read_b128 v[44:47], v0 offset:43008
  ds_read_b128 v[48:51], v0 offset:44032
  v_max3_f32 v16, v116, v117, v118
  v_max3_f32 v16, v16, v119, v120
  v_max3_f32 v16, v16, v121, v122
  s_nop 0
  v_mul_f32 v124, s23, v124
  v_mul_f32 v125, s23, v125
  v_max3_f32 v16, v16, v123, v124
  v_max_f32 v16, v16, v125
  v_mov_b32 v17, v16
  s_nop 1
  v_permlane16_swap_b32 v16, v17
  v_max_f32 v16, v16, v17
  v_mov_b32 v17, v16
  s_nop 1
  v_permlane32_swap_b32 v16, v17
  v_max_f32 v16, v16, v17
  v_sub_f32 v116, v116, v16
  v_exp_f32 v116, v116
  v_sub_f32 v117, v117, v16
  v_exp_f32 v117, v117
  v_sub_f32 v118, v118, v16
  v_exp_f32 v118, v118
  v_sub_f32 v119, v119, v16
  v_exp_f32 v119, v119
  v_sub_f32 v120, v120, v16
  v_exp_f32 v120, v120
  v_sub_f32 v121, v121, v16
  v_exp_f32 v121, v121
  v_sub_f32 v122, v122, v16
  v_exp_f32 v122, v122
  v_sub_f32 v123, v123, v16
  v_exp_f32 v123, v123
  v_sub_f32 v124, v124, v16
  v_exp_f32 v124, v124
  v_sub_f32 v125, v125, v16
  v_exp_f32 v125, v125
  v_cvt_pk_bf16_f32 v116, v116, v117
  v_cvt_pk_bf16_f32 v117, v118, v119
  v_cvt_pk_bf16_f32 v118, v120, v121
  v_cvt_pk_bf16_f32 v119, v122, v123
  v_cvt_pk_bf16_f32 v14, v124, v125
  v_cvt_pk_bf16_f32 v15, v124, v125
  s_waitcnt vmcnt(0)
  ds_read_b128 v[120:123], v11 offset:0
  ds_read_b128 v[124:127], v11 offset:1024
  v_mfma_f32_16x16x32_bf16 v[16:19], v[4:7], v[116:119], 0
  v_mfma_f32_16x16x16_bf16 v[16:19], v[12:13], v[14:15], v[16:19]
  s_waitcnt lgkmcnt(2)
  v_mfma_f32_16x16x32_bf16 v[20:23], v[36:39], v[116:119], 0
  v_mfma_f32_16x16x32_bf16 v[24:27], v[40:43], v[116:119], 0
  v_mfma_f32_16x16x32_bf16 v[28:31], v[44:47], v[116:119], 0
  v_mfma_f32_16x16x32_bf16 v[32:35], v[48:51], v[116:119], 0
  s_waitcnt lgkmcnt(0)
  v_mfma_f32_16x16x16_bf16 v[20:23], v[120:121], v[14:15], v[20:23]
  v_mfma_f32_16x16x16_bf16 v[24:27], v[122:123], v[14:15], v[24:27]
  v_mfma_f32_16x16x16_bf16 v[28:31], v[124:125], v[14:15], v[28:31]
  v_mfma_f32_16x16x16_bf16 v[32:35], v[126:127], v[14:15], v[32:35]
  v_rcp_f32 v16, v18
  s_lshl_b32 s10, s25, 11
  s_add_u32 s10, s10, s29
  v_add_u32 v0, s10, v1
  v_add_u32 v11, 0x18000, v1
  v_mul_f32 v20, v16, v20
  v_mul_f32 v21, v16, v21
  v_mul_f32 v22, v16, v22
  v_mul_f32 v23, v16, v23
  v_mul_f32 v24, v16, v24
  v_mul_f32 v25, v16, v25
  v_mul_f32 v26, v16, v26
  v_mul_f32 v27, v16, v27
  v_cvt_pk_bf16_f32 v20, v20, v21
  v_cvt_pk_bf16_f32 v21, v22, v23
  v_cvt_pk_bf16_f32 v22, v24, v25
  v_cvt_pk_bf16_f32 v23, v26, v27
  ds_write_b128 v0, v[20:23] offset:12288
  v_mul_f32 v28, v16, v28
  v_mul_f32 v29, v16, v29
  v_mul_f32 v30, v16, v30
  v_mul_f32 v31, v16, v31
  v_mul_f32 v32, v16, v32
  v_mul_f32 v33, v16, v33
  v_mul_f32 v34, v16, v34
  v_mul_f32 v35, v16, v35
  v_cvt_pk_bf16_f32 v28, v28, v29
  v_cvt_pk_bf16_f32 v29, v30, v31
  v_cvt_pk_bf16_f32 v30, v32, v33
  v_cvt_pk_bf16_f32 v31, v34, v35
  ds_write_b128 v0, v[28:31] offset:13312
  s_waitcnt lgkmcnt(0)
  s_barrier
  ds_read_b128 v[20:23], v11 offset:12288
  ds_read_b128 v[28:31], v11 offset:13312
  ds_read_b128 v[36:39], v11 offset:14336
  ds_read_b128 v[44:47], v11 offset:15360
  ds_read_b128 v[24:27], v11 offset:16384
  ds_read_b128 v[32:35], v11 offset:17408
  ds_read_b128 v[40:43], v11 offset:18432
  ds_read_b128 v[48:51], v11 offset:19456
  s_and_b32 s3, s19, 3
  s_lshl_b32 s10, s6, 2
  s_add_u32 s3, s3, s10
  s_add_u32 s10, s6, 16
  s_cmp_lt_u32 s19, s12
  s_cselect_b32 s3, s3, s10
  s_cbranch_scc1 L_C_nc
  buffer_load_dword v17, off, s[72:75], s79 sc1
L_C_nc:
  s_lshl_b32 s10, s3, 20
  s_lshl_b32 s11, s5, 10
  s_add_u32 s10, s10, s11
  s_add_u32 s10, s10, 0x3500000
  s_add_u32 s11, s10, 524288
  s_waitcnt lgkmcnt(7)
  v_mfma_f32_16x16x32_bf16 v[52:55], v[20:23], a[128:131], v[52:55]
  v_mfma_f32_16x16x32_bf16 v[56:59], v[20:23], a[136:139], v[56:59]
  v_mfma_f32_16x16x32_bf16 v[60:63], v[20:23], a[144:147], v[60:63]
  v_mfma_f32_16x16x32_bf16 v[64:67], v[20:23], a[152:155], v[64:67]
  v_mfma_f32_16x16x32_bf16 v[68:71], v[20:23], a[160:163], v[68:71]
  v_mfma_f32_16x16x32_bf16 v[72:75], v[20:23], a[168:171], v[72:75]
  v_mfma_f32_16x16x32_bf16 v[76:79], v[20:23], a[176:179], v[76:79]
  v_mfma_f32_16x16x32_bf16 v[80:83], v[20:23], a[184:187], v[80:83]
  s_waitcnt lgkmcnt(6)
  v_mfma_f32_16x16x32_bf16 v[52:55], v[28:31], a[132:135], v[52:55]
  v_mfma_f32_16x16x32_bf16 v[56:59], v[28:31], a[140:143], v[56:59]
  v_mfma_f32_16x16x32_bf16 v[60:63], v[28:31], a[148:151], v[60:63]
  v_mfma_f32_16x16x32_bf16 v[64:67], v[28:31], a[156:159], v[64:67]
  v_mfma_f32_16x16x32_bf16 v[68:71], v[28:31], a[164:167], v[68:71]
  v_mfma_f32_16x16x32_bf16 v[72:75], v[28:31], a[172:175], v[72:75]
  v_mfma_f32_16x16x32_bf16 v[76:79], v[28:31], a[180:183], v[76:79]
  v_mfma_f32_16x16x32_bf16 v[80:83], v[28:31], a[188:191], v[80:83]
  s_waitcnt lgkmcnt(5)
  v_mfma_f32_16x16x32_bf16 v[52:55], v[36:39], a[192:195], v[52:55]
  v_mfma_f32_16x16x32_bf16 v[56:59], v[36:39], a[200:203], v[56:59]
  v_mfma_f32_16x16x32_bf16 v[60:63], v[36:39], a[208:211], v[60:63]
  v_mfma_f32_16x16x32_bf16 v[64:67], v[36:39], a[216:219], v[64:67]
  v_mfma_f32_16x16x32_bf16 v[68:71], v[36:39], a[224:227], v[68:71]
  v_mfma_f32_16x16x32_bf16 v[72:75], v[36:39], a[232:235], v[72:75]
  v_mfma_f32_16x16x32_bf16 v[76:79], v[36:39], a[240:243], v[76:79]
  v_mfma_f32_16x16x32_bf16 v[80:83], v[36:39], a[248:251], v[80:83]
  s_waitcnt lgkmcnt(4)
  v_mfma_f32_16x16x32_bf16 v[52:55], v[44:47], a[196:199], v[52:55]
  v_mfma_f32_16x16x32_bf16 v[56:59], v[44:47], a[204:207], v[56:59]
  v_mfma_f32_16x16x32_bf16 v[60:63], v[44:47], a[212:215], v[60:63]
  v_mfma_f32_16x16x32_bf16 v[64:67], v[44:47], a[220:223], v[64:67]
  v_mfma_f32_16x16x32_bf16 v[68:71], v[44:47], a[228:231], v[68:71]
  v_mfma_f32_16x16x32_bf16 v[72:75], v[44:47], a[236:239], v[72:75]
  v_mfma_f32_16x16x32_bf16 v[76:79], v[44:47], a[244:247], v[76:79]
  v_mfma_f32_16x16x32_bf16 v[80:83], v[44:47], a[252:255], v[80:83]
  s_waitcnt lgkmcnt(3)
  v_mfma_f32_16x16x32_bf16 v[84:87], v[24:27], a[128:131], v[84:87]
  v_mfma_f32_16x16x32_bf16 v[88:91], v[24:27], a[136:139], v[88:91]
  v_mfma_f32_16x16x32_bf16 v[92:95], v[24:27], a[144:147], v[92:95]
  v_mfma_f32_16x16x32_bf16 v[96:99], v[24:27], a[152:155], v[96:99]
  v_mfma_f32_16x16x32_bf16 v[100:103], v[24:27], a[160:163], v[100:103]
  v_cvt_pk_bf16_f32 v20, v52, v56
  v_mfma_f32_16x16x32_bf16 v[104:107], v[24:27], a[168:171], v[104:107]
  v_cvt_pk_bf16_f32 v21, v60, v64
  v_mfma_f32_16x16x32_bf16 v[108:111], v[24:27], a[176:179], v[108:111]
  v_cvt_pk_bf16_f32 v22, v68, v72
  v_mfma_f32_16x16x32_bf16 v[112:115], v[24:27], a[184:187], v[112:115]
  v_cvt_pk_bf16_f32 v23, v76, v80
  s_waitcnt lgkmcnt(2)
  v_mfma_f32_16x16x32_bf16 v[84:87], v[32:35], a[132:135], v[84:87]
  s_add_u32 s11, s10, 0
  buffer_store_dwordx4 v[20:23], v8, s[72:75], s11 offen sc1
  v_mfma_f32_16x16x32_bf16 v[88:91], v[32:35], a[140:143], v[88:91]
  v_cvt_pk_bf16_f32 v28, v53, v57
  v_mfma_f32_16x16x32_bf16 v[92:95], v[32:35], a[148:151], v[92:95]
  v_cvt_pk_bf16_f32 v29, v61, v65
  v_mfma_f32_16x16x32_bf16 v[96:99], v[32:35], a[156:159], v[96:99]
  v_cvt_pk_bf16_f32 v30, v69, v73
  v_mfma_f32_16x16x32_bf16 v[100:103], v[32:35], a[164:167], v[100:103]
  v_cvt_pk_bf16_f32 v31, v77, v81
  v_mfma_f32_16x16x32_bf16 v[104:107], v[32:35], a[172:175], v[104:107]
  s_add_u32 s11, s10, 32768
  buffer_store_dwordx4 v[28:31], v8, s[72:75], s11 offen sc1
  v_mfma_f32_16x16x32_bf16 v[108:111], v[32:35], a[180:183], v[108:111]
  v_cvt_pk_bf16_f32 v36, v54, v58
  v_mfma_f32_16x16x32_bf16 v[112:115], v[32:35], a[188:191], v[112:115]
  v_cvt_pk_bf16_f32 v37, v62, v66
  s_waitcnt lgkmcnt(1)
  v_mfma_f32_16x16x32_bf16 v[84:87], v[40:43], a[192:195], v[84:87]
  v_cvt_pk_bf16_f32 v38, v70, v74
  v_mfma_f32_16x16x32_bf16 v[88:91], v[40:43], a[200:203], v[88:91]
  v_cvt_pk_bf16_f32 v39, v78, v82
  v_mfma_f32_16x16x32_bf16 v[92:95], v[40:43], a[208:211], v[92:95]
  s_add_u32 s11, s10, 65536
  buffer_store_dwordx4 v[36:39], v8, s[72:75], s11 offen sc1
  v_mfma_f32_16x16x32_bf16 v[96:99], v[40:43], a[216:219], v[96:99]
  v_cvt_pk_bf16_f32 v44, v55, v59
  v_mfma_f32_16x16x32_bf16 v[100:103], v[40:43], a[224:227], v[100:103]
  v_cvt_pk_bf16_f32 v45, v63, v67
  v_mfma_f32_16x16x32_bf16 v[104:107], v[40:43], a[232:235], v[104:107]
  v_cvt_pk_bf16_f32 v46, v71, v75
  v_mfma_f32_16x16x32_bf16 v[108:111], v[40:43], a[240:243], v[108:111]
  v_cvt_pk_bf16_f32 v47, v79, v83
  v_mfma_f32_16x16x32_bf16 v[112:115], v[40:43], a[248:251], v[112:115]
  s_add_u32 s11, s10, 98304
  buffer_store_dwordx4 v[44:47], v8, s[72:75], s11 offen sc1
  s_waitcnt lgkmcnt(0)
  v_mfma_f32_16x16x32_bf16 v[84:87], v[48:51], a[196:199], v[84:87]
  v_mfma_f32_16x16x32_bf16 v[88:91], v[48:51], a[204:207], v[88:91]
  v_mfma_f32_16x16x32_bf16 v[92:95], v[48:51], a[212:215], v[92:95]
  v_mfma_f32_16x16x32_bf16 v[96:99], v[48:51], a[220:223], v[96:99]
  v_mfma_f32_16x16x32_bf16 v[100:103], v[48:51], a[228:231], v[100:103]
  v_mfma_f32_16x16x32_bf16 v[104:107], v[48:51], a[236:239], v[104:107]
  v_mfma_f32_16x16x32_bf16 v[108:111], v[48:51], a[244:247], v[108:111]
  v_mfma_f32_16x16x32_bf16 v[112:115], v[48:51], a[252:255], v[112:115]
  v_cvt_pk_bf16_f32 v24, v84, v88
  v_cvt_pk_bf16_f32 v25, v92, v96
  v_cvt_pk_bf16_f32 v26, v100, v104
  s_nop 4
  v_cvt_pk_bf16_f32 v27, v108, v112
  s_add_u32 s11, s10, 524288
  buffer_store_dwordx4 v[24:27], v8, s[72:75], s11 offen sc1
  v_cvt_pk_bf16_f32 v32, v85, v89
  v_cvt_pk_bf16_f32 v33, v93, v97
  v_cvt_pk_bf16_f32 v34, v101, v105
  v_cvt_pk_bf16_f32 v35, v109, v113
  s_add_u32 s11, s10, 557056
  buffer_store_dwordx4 v[32:35], v8, s[72:75], s11 offen sc1
  v_cvt_pk_bf16_f32 v40, v86, v90
  v_cvt_pk_bf16_f32 v41, v94, v98
  v_cvt_pk_bf16_f32 v42, v102, v106
  v_cvt_pk_bf16_f32 v43, v110, v114
  s_add_u32 s11, s10, 589824
  buffer_store_dwordx4 v[40:43], v8, s[72:75], s11 offen sc1
  v_cvt_pk_bf16_f32 v48, v87, v91
  v_cvt_pk_bf16_f32 v49, v95, v99
  v_cvt_pk_bf16_f32 v50, v103, v107
  v_cvt_pk_bf16_f32 v51, v111, v115
  s_add_u32 s11, s10, 622592
  buffer_store_dwordx4 v[48:51], v8, s[72:75], s11 offen sc1
  v_xor_b32 v2, 0xc000, v2
  s_add_u32 s27, s27, 4
  s_add_u32 s21, s21, 1048576
  s_cmp_lt_u32 s19, s12
  s_cbranch_scc1 L_C
  s_add_u32 s10, s6, 16
  s_lshl_b32 s10, s10, 5
  s_add_u32 s10, s10, s5
  s_lshl_b32 s10, s10, 15
  s_add_u32 s80, s10, 0x3500000
  s_add_u32 s10, s16, 131072
  buffer_load_dword v168, v10, s[32:35], s10 offen
  s_add_u32 s81, s80, 4096
  s_add_u32 s82, s80, 8192
  s_add_u32 s83, s80, 12288
  s_add_u32 s84, s80, 16384
  s_add_u32 s85, s80, 20480
  s_add_u32 s86, s80, 24576
  s_add_u32 s87, s80, 28672
  s_waitcnt vmcnt(9)
  s_mov_b32 s14, 0
L_rg_18:
  v_readfirstlane_b32 s10, v17
  s_nop 0
  s_cmp_ge_u32 s10, 32
  s_cbranch_scc1 L_rg_18k
  s_sleep 8
  buffer_load_dword v17, off, s[72:75], s79 sc1
  s_add_u32 s14, s14, 1
  s_cmp_gt_u32 s14, 200000
  s_cbranch_scc1 L_end
  s_waitcnt vmcnt(0)
  s_branch L_rg_18
L_rg_18k:
  buffer_load_dword v19, v10, s[32:35], s16 offen
  s_add_u32 m0, s77, 0
  s_nop 0
  buffer_load_dwordx4 v9, s[72:75], s17 offen sc1 lds
  s_add_u32 s17, s17, 4096
  s_add_u32 m0, s77, 1024
  s_nop 0
  buffer_load_dwordx4 v9, s[72:75], s17 offen sc1 lds
  s_add_u32 s17, s17, 4096
  s_add_u32 m0, s77, 2048
  s_nop 0
  buffer_load_dwordx4 v9, s[72:75], s17 offen sc1 lds
  s_add_u32 s17, s17, 4096
  s_add_u32 m0, s77, 3072
  s_nop 0
  buffer_load_dwordx4 v9, s[72:75], s17 offen sc1 lds
  s_add_u32 s17, s17, 4096
  s_add_u32 m0, s77, 4096
  s_nop 0
  buffer_load_dwordx4 v9, s[72:75], s17 offen sc1 lds
  s_add_u32 s17, s17, 4096
  s_add_u32 m0, s77, 5120
  s_nop 0
  buffer_load_dwordx4 v9, s[72:75], s17 offen sc1 lds
  s_add_u32 s17, s17, 4096
  s_add_u32 m0, s77, 6144
  s_nop 0
  buffer_load_dwordx4 v9, s[72:75], s17 offen sc1 lds
  s_add_u32 s17, s17, 4096
  s_add_u32 m0, s77, 7168
  s_nop 0
  buffer_load_dwordx4 v9, s[72:75], s17 offen sc1 lds
  s_waitcnt vmcnt(10)
  buffer_load_dwordx4 v[128:131], v9, s[72:75], s80 offen sc1
  buffer_load_dwordx4 v[132:135], v9, s[72:75], s81 offen sc1
  buffer_load_dwordx4 v[136:139], v9, s[72:75], s82 offen sc1
  buffer_load_dwordx4 v[140:143], v9, s[72:75], s83 offen sc1
  buffer_load_dwordx4 v[144:147], v9, s[72:75], s84 offen sc1
  buffer_load_dwordx4 v[148:151], v9, s[72:75], s85 offen sc1
  buffer_load_dwordx4 v[152:155], v9, s[72:75], s86 offen sc1
  buffer_load_dwordx4 v[156:159], v9, s[72:75], s87 offen sc1
  v_add_u32 v0, s77, v1
  s_waitcnt vmcnt(8)
  ds_read_b128 v[36:39], v0 offset:0
  ds_read_b128 v[40:43], v0 offset:1024
  ds_read_b128 v[44:47], v0 offset:2048
  ds_read_b128 v[48:51], v0 offset:3072
  s_waitcnt lgkmcnt(3)
  v_mfma_f32_16x16x32_bf16 v[124:127], v[4:7], v[36:39], 0
  s_waitcnt lgkmcnt(2)
  v_mfma_f32_16x16x32_bf16 v[124:127], v[4:7], v[40:43], v[124:127]
  s_waitcnt lgkmcnt(1)
  v_mfma_f32_16x16x32_bf16 v[124:127], v[4:7], v[44:47], v[124:127]
  s_waitcnt lgkmcnt(0)
  v_mfma_f32_16x16x32_bf16 v[124:127], v[4:7], v[48:51], v[124:127]
  ds_read_b128 v[36:39], v0 offset:4096
  ds_read_b128 v[40:43], v0 offset:5120
  ds_read_b128 v[44:47], v0 offset:6144
  ds_read_b128 v[48:51], v0 offset:7168
  s_waitcnt lgkmcnt(3)
  v_mfma_f32_16x16x32_bf16 v[124:127], v[4:7], v[36:39], v[124:127]
  s_waitcnt lgkmcnt(2)
  v_mfma_f32_16x16x32_bf16 v[124:127], v[4:7], v[40:43], v[124:127]
  s_waitcnt lgkmcnt(1)
  v_mfma_f32_16x16x32_bf16 v[124:127], v[4:7], v[44:47], v[124:127]
  s_waitcnt lgkmcnt(0)
  v_mfma_f32_16x16x32_bf16 v[124:127], v[4:7], v[48:51], v[124:127]
  s_nop 7
  v_cndmask_b32_e64 v126, v125, v124, s[36:37]
  s_nop 1
  v_mov_b32_dpp v126, v126 quad_perm:[1,0,3,2] row_mask:0xf bank_mask:0xf
  v_cndmask_b32_e64 v124, v124, v126, s[36:37]
  v_cndmask_b32_e64 v125, v126, v125, s[36:37]
  v_lshlrev_b32 v0, 16, v19
  v_and_b32 v11, 0xffff0000, v19
  v_add_f32 v0, v0, v124
  v_add_f32 v11, v11, v125
  v_cvt_pk_bf16_f32 v0, v0, v11
  buffer_store_dword v0, v10, s[64:67], s16 offen
  s_add_u32 s7, s7, 4
  s_add_u32 s8, s8, 1
  s_lshl_b32 s10, s7, 5
  s_add_u32 s10, s10, s5
  s_lshl_b32 s16, s10, 10
  s_and_b32 s17, s8, 3
  s_lshl_b32 s10, s6, 2
  s_add_u32 s17, s17, s10
  s_lshl_b32 s17, s17, 5
  s_add_u32 s17, s17, s5
  s_lshl_b32 s17, s17, 15
  s_add_u32 s17, s17, 0x3500000
  s_lshl_b32 s79, s7, 7
  s_add_u32 s79, s79, 0x6000
  s_mov_b32 s14, 0
  s_branch L_C_rq
L_C_rp:
  buffer_load_dwordx4 v[128:131], v9, s[72:75], s80 offen sc1
  buffer_load_dwordx4 v[132:135], v9, s[72:75], s81 offen sc1
  buffer_load_dwordx4 v[136:139], v9, s[72:75], s82 offen sc1
  buffer_load_dwordx4 v[140:143], v9, s[72:75], s83 offen sc1
  buffer_load_dwordx4 v[144:147], v9, s[72:75], s84 offen sc1
  buffer_load_dwordx4 v[148:151], v9, s[72:75], s85 offen sc1
  buffer_load_dwordx4 v[152:155], v9, s[72:75], s86 offen sc1
  buffer_load_dwordx4 v[156:159], v9, s[72:75], s87 offen sc1
  s_add_u32 s14, s14, 1
  s_cmp_gt_u32 s14, 200000
  s_cbranch_scc1 L_end
L_C_rq:
  s_waitcnt vmcnt(7)
  v_max3_u32 v16, v128, v129, 0
  v_max3_u32 v16, v130, v131, v16
  s_waitcnt vmcnt(6)
  v_max3_u32 v16, v132, v133, v16
  v_max3_u32 v16, v134, v135, v16
  s_waitcnt vmcnt(5)
  v_max3_u32 v16, v136, v137, v16
  v_max3_u32 v16, v138, v139, v16
  s_waitcnt vmcnt(4)
  v_max3_u32 v16, v140, v141, v16
  v_max3_u32 v16, v142, v143, v16
  s_waitcnt vmcnt(3)
  v_max3_u32 v16, v144, v145, v16
  v_max3_u32 v16, v146, v147, v16
  s_waitcnt vmcnt(2)
  v_max3_u32 v16, v148, v149, v16
  v_max3_u32 v16, v150, v151, v16
  s_waitcnt vmcnt(1)
  v_max3_u32 v16, v152, v153, v16
  v_max3_u32 v16, v154, v155, v16
  s_waitcnt vmcnt(0)
  v_max3_u32 v16, v156, v157, v16
  v_max3_u32 v16, v158, v159, v16
  v_cmp_eq_u32 vcc, -1, v16
  s_nop 0
  s_and_b64 exec, exec, vcc
  s_cbranch_scc1 L_C_rp
  s_mov_b64 exec, -1
  v_mfma_f32_16x16x32_bf16 v[124:127], v[4:7], v[128:131], 0
  v_mfma_f32_16x16x32_bf16 v[124:127], v[4:7], v[132:135], v[124:127]
  v_mfma_f32_16x16x32_bf16 v[124:127], v[4:7], v[136:139], v[124:127]
  v_mfma_f32_16x16x32_bf16 v[124:127], v[4:7], v[140:143], v[124:127]
  v_mfma_f32_16x16x32_bf16 v[124:127], v[4:7], v[144:147], v[124:127]
  v_mfma_f32_16x16x32_bf16 v[124:127], v[4:7], v[148:151], v[124:127]
  v_mfma_f32_16x16x32_bf16 v[124:127], v[4:7], v[152:155], v[124:127]
  v_mfma_f32_16x16x32_bf16 v[124:127], v[4:7], v[156:159], v[124:127]
  s_nop 7
  v_cndmask_b32_e64 v126, v125, v124, s[36:37]
  s_nop 1
  v_mov_b32_dpp v126, v126 quad_perm:[1,0,3,2] row_mask:0xf bank_mask:0xf
  s_nop 5
  v_cndmask_b32_e64 v124, v124, v126, s[36:37]
  v_cndmask_b32_e64 v125, v126, v125, s[36:37]
  v_lshlrev_b32 v0, 16, v168
  v_and_b32 v11, 0xffff0000, v168
  v_add_f32 v0, v0, v124
  v_add_f32 v11, v11, v125
  v_cvt_pk_bf16_f32 v0, v0, v11
  buffer_store_dword v0, v10, s[64:67], s16 offen
  s_endpgm
  s_endpgm
L_restart:
  s_bitcmp1_b32 s94, 8
  s_cbranch_scc1 L_end
  s_bitset1_b32 s94, 8
  s_mov_b32 s95, s10
  s_mov_b64 exec, -1
  s_waitcnt vmcnt(0) lgkmcnt(0)
  s_barrier
  v_mbcnt_lo_u32_b32 v0, -1, 0
  v_mbcnt_hi_u32_b32 v0, -1, v0
  s_lshl_b32 s10, s4, 6
  v_add_u32 v0, s10, v0
  s_branch L_again
L_end:
  s_endpgm
.section .rodata,"a"
.p2align 6
.amdhsa_kernel parallel_sum__memory_aug_recurrent_mem_tr__dense_activation_relu__prompt_kernel
  .amdhsa_next_free_vgpr 512
  .amdhsa_next_free_sgpr 102
  .amdhsa_accum_offset 256
  .amdhsa_group_segment_fixed_size 0
  .amdhsa_kernarg_size 104
  .amdhsa_user_sgpr_count 2
  .amdhsa_user_sgpr_kernarg_segment_ptr 1
  .amdhsa_system_sgpr_workgroup_id_x 1
.end_amdhsa_kernel
```
